```python
import torch

def _softmax(x, axis=-1):
    return torch.softmax(x, dim=axis)

def _gelu(x):
    return torch.nn.functional.gelu(x, approximate='tanh')

def _silu(x):
    return torch.nn.functional.silu(x)

def _sigmoid(x):
    return torch.sigmoid(x)

def _layernorm(x, axis=-1, eps=1e-05):
    m = x.mean(dim=axis, keepdim=True)
    v = x.var(dim=axis, keepdim=True, unbiased=False)
    return (x - m) / torch.sqrt(v + eps)

def _scatter_add(tgt, idx, src, axis=0):
    return tgt.clone().index_add_(axis, idx, src)

def _segment_sum(src, seg, n):
    out = torch.zeros((n,) + src.shape[1:], dtype=src.dtype)
    return out.index_add_(0, seg, src)

def _pad(x, pw):
    flat = tuple((v for pair in reversed(pw) for v in pair))
    return torch.nn.functional.pad(x, flat)
kernel_name = 'standalone__tensor_product_equiv_mace__graph'

def setup_inputs():

    _w = lambda a: (lambda t: t.to(torch.bfloat16) if t.is_floating_point() else t)(torch.as_tensor(a))
    N, deg = (10000, 32)
    Lmax, C, De = (1, 128, 16)
    M = (Lmax + 1) ** 2
    E = N * deg
    src = (lambda lo, hi, *s: torch.randint(lo, hi, s))(0, N, E).to(torch.int64)
    dst = (lambda lo, hi, *s: torch.randint(lo, hi, s))(0, N, E).to(torch.int64)
    r = (lambda *s: torch.randn(*s, dtype=torch.bfloat16) * 0.05)(E, 3).to(float)
    r = r / (torch.linalg.norm(r, dim=-1, keepdim=True).to(float) + 1e-06)
    rx, ry, rz = (r[:, 0].clone(), r[:, 1].clone(), r[:, 2].clone())
    x2, y2, z2 = (rx * rx, ry * ry, rz * rz)
    sh_list = [torch.ones_like(rx), rx, ry, rz, rx * ry, ry * rz, 2.0 * z2 - x2 - y2, rx * rz, x2 - y2, ry * (3.0 * x2 - y2), rx * ry * rz, ry * (4.0 * z2 - x2 - y2), rz * (2.0 * z2 - 3.0 * x2 - 3.0 * y2), rx * (4.0 * z2 - x2 - y2), rz * (x2 - y2), rx * (x2 - 3.0 * y2)]
    sh16 = torch.stack(sh_list, dim=-1).to(float)
    pad = max(0, M - 16)
    sh_full = torch.cat([sh16, torch.zeros((E, pad), dtype=float)], dim=-1)[:, :M]
    cg = ((lambda *s: torch.randn(*s, dtype=torch.bfloat16) * 0.05)(M, M, M) * (1.0 / float(M))).to(float)
    return {'x': _w(((lambda *s: torch.randn(*s, dtype=torch.bfloat16) * 0.05)(N, M, C) * 0.3).to(float)), 'src': _w(src), 'dst': _w(dst), 'sh': _w(sh_full.to(float)), 'edge_attr': _w(((lambda *s: torch.randn(*s, dtype=torch.bfloat16) * 0.05)(E, De) * 0.3).to(float)), 'cg': _w(cg), 'w_r': _w(((lambda *s: torch.randn(*s, dtype=torch.bfloat16) * 0.05)(De, C) * (1.0 / float(De) ** 0.5)).to(float)), 'w_out': _w(((lambda *s: torch.randn(*s, dtype=torch.bfloat16) * 0.05)(C, C) * (1.0 / float(C) ** 0.5)).to(float))}

def reference(x, src, dst, sh, edge_attr, cg, w_r, w_out):
    N = x.shape[0]
    M = x.shape[1]
    C = x.shape[2]
    h = x[src]
    tp = torch.einsum('uvw,euc,ev->ewc', cg, h, sh)
    rw = edge_attr @ w_r
    msg = tp * rw[:, None, :]
    msg2 = msg.reshape(-1, M * C)
    agg = _segment_sum(msg2, dst, N).reshape(N, M, C)
    out = torch.einsum('nmc,cd->nmd', agg, w_out)
    return out
```

```asm
; @launch kernel=mace_prep_kernel grid=(250,1,1) block=(640,1,1) lds=63488
; @launch kernel=standalone__tensor_product_equiv_mace__graph_kernel grid=(256,1,1) block=(512,1,1) lds=163744
.amdgcn_target "amdgcn-amd-amdhsa--gfx950"
.text
.globl mace_prep_kernel
.globl standalone__tensor_product_equiv_mace__graph_kernel
.p2align 8
.type mace_prep_kernel,@function
mace_prep_kernel:
    s_cmp_ge_u32 s2, 250
    s_cbranch_scc1 K1_END
    s_load_dwordx16 s[4:19], s[0:1], 0
    s_load_dwordx2 s[20:21], s[0:1], 80
    s_getpc_b64 s[68:69]
K1_PC:
    v_lshlrev_b32 v82, 7, v0
    v_cmp_gt_u32 vcc, 20, v0
    s_and_saveexec_b64 s[54:55], vcc
    global_load_dword v83, v82, s[68:69]
    s_mov_b64 exec, s[54:55]
    v_lshlrev_b32 v1, 2, v0
    v_lshlrev_b32 v2, 3, v0
    v_lshlrev_b32 v3, 4, v0
    v_lshrrev_b32 v6, 6, v0
    v_and_b32 v4, 63, v0
    v_lshlrev_b32 v4, 2, v4
    v_readfirstlane_b32 s22, v6
    v_mov_b32 v5, 1
    v_mov_b32 v7, 0
    v_cmp_gt_u32 vcc, 0x100, v0
    s_and_saveexec_b64 s[54:55], vcc
    ds_write_b32 v1, v7
    s_mov_b64 exec, s[54:55]
    s_mul_i32 s23, s2, 1280
    s_lshl_b32 s52, s23, 2
    s_lshl_b32 s53, s23, 3
    s_lshl_b32 s55, s23, 5
    s_waitcnt lgkmcnt(0)
    s_mov_b32 s24, s8
    s_mov_b32 s25, s9
    s_mov_b32 s26, 0x138800
    s_mov_b32 s27, 0x00020000
    s_mov_b32 s28, s6
    s_mov_b32 s29, s7
    s_mov_b32 s30, 0x138800
    s_mov_b32 s31, 0x00020000
    s_mov_b32 s32, s10
    s_mov_b32 s33, s11
    s_mov_b32 s34, 0x271000
    s_mov_b32 s35, 0x00020000
    s_mov_b32 s36, s12
    s_mov_b32 s37, s13
    s_mov_b32 s38, 0x9c4000
    s_mov_b32 s39, 0x00020000
    buffer_load_dword v8, v1, s[24:27], s52 offen offset:0 nt
    buffer_load_dword v9, v1, s[24:27], s52 offen offset:2560 nt
    buffer_load_dword v10, v1, s[28:31], s52 offen offset:0 nt
    buffer_load_dword v11, v1, s[28:31], s52 offen offset:2560 nt
    buffer_load_dwordx2 v[16:17], v2, s[32:35], s53 offen offset:0 nt
    s_add_u32 s54, s53, 5120
    buffer_load_dwordx2 v[18:19], v2, s[32:35], s54 offen nt
    s_barrier
    buffer_load_dwordx4 v[28:31], v3, s[36:39], s55 offen offset:0 nt
    s_add_u32 s54, s55, 10240
    buffer_load_dwordx4 v[32:35], v3, s[36:39], s54 offen nt
    s_add_u32 s54, s55, 20480
    buffer_load_dwordx4 v[36:39], v3, s[36:39], s54 offen nt
    s_add_u32 s54, s55, 30720
    buffer_load_dwordx4 v[40:43], v3, s[36:39], s54 offen nt
    s_mov_b32 s44, s20
    s_mov_b32 s45, s21
    s_mov_b32 s46, 0x1338800
    s_mov_b32 s47, 0x00020000
    s_mov_b32 s67, 0
    s_cmp_ge_u32 s2, 37
    s_cbranch_scc1 K1_NOFR
    s_cmp_ge_u32 s22, 4
    s_cbranch_scc1 K1_NOFR
    s_mov_b32 s67, 1
    s_cmp_ge_u32 s2, 32
    s_cbranch_scc1 K1_FR2
    s_mov_b32 s48, s18
    s_mov_b32 s49, s19
    s_mov_b32 s50, 32768
    s_mov_b32 s51, 0x00020000
    v_lshrrev_b32 v76, 6, v0
    v_lshlrev_b32 v76, 10, v76
    v_and_b32 v77, 3, v0
    v_lshl_or_b32 v76, v77, 8, v76
    v_bfe_u32 v77, v0, 4, 2
    v_lshl_or_b32 v76, v77, 4, v76
    v_bfe_u32 v77, v0, 2, 2
    v_lshl_or_b32 v76, v77, 1, v76
    s_and_b32 s60, s2, 3
    s_lshl_b32 s60, s60, 12
    s_lshr_b32 s61, s2, 3
    s_lshl_b32 s61, s61, 6
    s_add_u32 s60, s60, s61
    s_bfe_u32 s61, s2, 0x10002
    s_lshl_b32 s61, s61, 3
    s_add_u32 s60, s60, s61
    v_add_u32 v77, 16384, v76
    s_lshl_b32 s62, s2, 10
    s_add_u32 s62, s62, 0x1100000
    s_branch K1_FRLD
K1_FR2:
    s_cmp_eq_u32 s2, 36
    s_cbranch_scc1 K1_FR3
    s_mov_b32 s48, s16
    s_mov_b32 s49, s17
    s_mov_b32 s50, 4096
    s_mov_b32 s51, 0x00020000
    v_lshrrev_b32 v76, 7, v0
    v_lshlrev_b32 v76, 11, v76
    v_and_b32 v77, 3, v0
    v_lshl_or_b32 v76, v77, 9, v76
    v_bfe_u32 v77, v0, 2, 5
    v_lshl_or_b32 v76, v77, 1, v76
    s_and_b32 s60, s2, 1
    s_lshl_b32 s60, s60, 6
    s_bfe_u32 s61, s2, 0x10001
    s_lshl_b32 s61, s61, 7
    s_add_u32 s60, s60, s61
    v_add_u32 v77, 256, v76
    s_sub_u32 s62, s2, 32
    s_lshl_b32 s62, s62, 10
    s_add_u32 s62, s62, 0x1108000
    s_branch K1_FRLD
K1_FR3:
    s_mov_b32 s48, s14
    s_mov_b32 s49, s15
    s_mov_b32 s50, 128
    s_mov_b32 s51, 0x00020000
    v_lshrrev_b32 v76, 3, v0
    v_lshlrev_b32 v76, 5, v76
    v_and_b32 v77, 1, v0
    v_lshl_or_b32 v76, v77, 4, v76
    v_bfe_u32 v77, v0, 1, 2
    v_lshl_or_b32 v76, v77, 1, v76
    s_mov_b32 s60, 0
    v_add_u32 v77, 8, v76
    s_mov_b32 s62, 0x1109000
K1_FRLD:
    buffer_load_ushort v78, v76, s[48:51], s60 offen
    buffer_load_ushort v79, v77, s[48:51], s60 offen
K1_NOFR:
    s_cmp_lg_u32 s2, 40
    s_cbranch_scc1 K1_NOCPF
    s_cmp_lg_u32 s22, 0
    s_cbranch_scc1 K1_NOCPF
    s_add_u32 s68, s68, standalone__tensor_product_equiv_mace__graph_kernel-K1_PC
    s_addc_u32 s69, s69, 0
    v_lshlrev_b32 v82, 5, v4
    v_cmpx_gt_u32 vcc, K2_CODE_END-standalone__tensor_product_equiv_mace__graph_kernel, v82
    global_load_dword v83, v82, s[68:69]
    v_add_u32 v82, 8192, v82
    v_cmpx_gt_u32 vcc, K2_CODE_END-standalone__tensor_product_equiv_mace__graph_kernel, v82
    global_load_dword v83, v82, s[68:69]
    s_mov_b64 exec, -1
K1_NOCPF:
    s_waitcnt vmcnt(8)
    v_mul_u32_u24 v22, 0xcccd, v8
    v_lshrrev_b32 v22, 21, v22
    v_lshlrev_b32 v26, 2, v22
    ds_add_rtn_u32 v24, v26, v5
    v_mul_u32_u24 v23, 0xcccd, v9
    v_lshrrev_b32 v23, 21, v23
    v_lshlrev_b32 v27, 2, v23
    ds_add_rtn_u32 v25, v27, v5
    v_mul_u32_u24 v20, 40, v22
    v_sub_u32 v20, v8, v20
    v_lshlrev_b32 v20, 2, v20
    v_or_b32 v20, 0x80000000, v20
    v_mul_u32_u24 v21, 40, v23
    v_sub_u32 v21, v9, v21
    v_lshlrev_b32 v21, 2, v21
    v_or_b32 v21, 0x80000000, v21
    s_waitcnt vmcnt(6)
    v_lshl_or_b32 v20, v10, 10, v20
    v_lshl_or_b32 v21, v11, 10, v21
    s_waitcnt lgkmcnt(0)
    v_lshl_or_b32 v52, v24, 8, v22
    ds_write_b32 v1, v52 offset:2048
    v_lshl_or_b32 v53, v25, 8, v23
    ds_write_b32 v1, v53 offset:4608
    s_waitcnt lgkmcnt(0)
    s_barrier
    s_cmp_lg_u32 s22, 0
    s_cbranch_scc1 K1_NOSCAN
    v_lshlrev_b32 v6, 2, v4
    ds_read_b128 v[60:63], v6 offset:0
    s_waitcnt lgkmcnt(0)
    v_add_u32 v52, v60, v61
    v_add_u32 v53, v52, v62
    v_add_u32 v54, v53, v63
    v_mov_b32 v55, v54
    s_nop 1
    v_add_u32_dpp v55, v55, v55 row_shr:1 row_mask:0xf bank_mask:0xf bound_ctrl:0
    s_nop 1
    v_add_u32_dpp v55, v55, v55 row_shr:2 row_mask:0xf bank_mask:0xf bound_ctrl:0
    s_nop 1
    v_add_u32_dpp v55, v55, v55 row_shr:4 row_mask:0xf bank_mask:0xf bound_ctrl:0
    s_nop 1
    v_add_u32_dpp v55, v55, v55 row_shr:8 row_mask:0xf bank_mask:0xf bound_ctrl:0
    s_nop 1
    v_add_u32_dpp v55, v55, v55 row_bcast:15 row_mask:0xa bank_mask:0xf
    s_nop 1
    v_add_u32_dpp v55, v55, v55 row_bcast:31 row_mask:0xc bank_mask:0xf
    v_sub_u32 v64, v55, v54
    v_add_u32 v65, v64, v60
    v_add_u32 v66, v64, v52
    v_add_u32 v67, v64, v53
    ds_write_b128 v6, v[64:67] offset:1024
    v_add_u32 v68, s23, v64
    v_lshl_or_b32 v68, v60, 19, v68
    v_add_u32 v69, s23, v65
    v_lshl_or_b32 v69, v61, 19, v69
    v_add_u32 v70, s23, v66
    v_lshl_or_b32 v70, v62, 19, v70
    v_add_u32 v71, s23, v67
    v_lshl_or_b32 v71, v63, 19, v71
    s_lshl_b32 s60, s2, 10
    s_add_u32 s60, s60, 0x1000000
    buffer_store_dwordx4 v[68:71], v6, s[44:47], s60 offen sc1
    s_waitcnt lgkmcnt(0)
K1_NOSCAN:
    s_barrier
    ds_read_b32 v48, v26 offset:1024
    ds_read_b32 v49, v27 offset:1024
    v_lshrrev_b32 v6, 1, v0
    v_lshlrev_b32 v6, 2, v6
    ds_read_b32 v44, v6 offset:2048
    ds_read_b32 v45, v6 offset:3328
    ds_read_b32 v46, v6 offset:4608
    ds_read_b32 v47, v6 offset:5888
    s_mul_i32 s60, s23, 40
    v_and_b32 v7, 1, v0
    v_lshlrev_b32 v7, 4, v7
    v_add_u32 v7, 7168, v7
    s_waitcnt lgkmcnt(4)
    v_add_u32 v48, v48, v24
    v_lshlrev_b32 v52, 2, v48
    v_add_u32 v52, 58368, v52
    ds_write_b32 v52, v20
    v_mul_u32_u24 v24, 40, v48
    v_add_u32 v49, v49, v25
    v_lshlrev_b32 v53, 2, v49
    v_add_u32 v53, 58368, v53
    ds_write_b32 v53, v21
    v_mul_u32_u24 v25, 40, v49
    s_waitcnt lgkmcnt(0)
    v_and_b32 v48, 0xff, v44
    v_lshlrev_b32 v48, 2, v48
    ds_read_b32 v48, v48 offset:1024
    v_and_b32 v49, 0xff, v45
    v_lshlrev_b32 v49, 2, v49
    ds_read_b32 v49, v49 offset:1024
    v_and_b32 v50, 0xff, v46
    v_lshlrev_b32 v50, 2, v50
    ds_read_b32 v50, v50 offset:1024
    v_and_b32 v51, 0xff, v47
    v_lshlrev_b32 v51, 2, v51
    ds_read_b32 v51, v51 offset:1024
    s_waitcnt vmcnt(4)
    ds_write_b64 v24, v[16:17] offset:7200
    ds_write_b64 v25, v[18:19] offset:7200
    v_lshrrev_b32 v44, 8, v44
    v_lshrrev_b32 v45, 8, v45
    v_lshrrev_b32 v46, 8, v46
    v_lshrrev_b32 v47, 8, v47
    s_waitcnt lgkmcnt(2)
    v_add_u32 v48, v48, v44
    v_mad_u32_u24 v48, v48, 40, v7
    v_add_u32 v49, v49, v45
    v_mad_u32_u24 v49, v49, 40, v7
    v_add_u32 v50, v50, v46
    v_mad_u32_u24 v50, v50, 40, v7
    v_add_u32 v51, v51, v47
    v_mad_u32_u24 v51, v51, 40, v7
    s_waitcnt vmcnt(3)
    ds_write2_b64 v48, v[28:29], v[30:31] offset0:0 offset1:1
    s_waitcnt vmcnt(2)
    ds_write2_b64 v49, v[32:33], v[34:35] offset0:0 offset1:1
    s_waitcnt vmcnt(1)
    ds_write2_b64 v50, v[36:37], v[38:39] offset0:0 offset1:1
    s_waitcnt vmcnt(0)
    ds_write2_b64 v51, v[40:41], v[42:43] offset0:0 offset1:1
    s_waitcnt lgkmcnt(0)
    s_barrier
    v_add_u32 v6, 7168, v3
    ds_read_b128 v[28:31], v6 offset:0
    ds_read_b128 v[32:35], v6 offset:10240
    ds_read_b128 v[36:39], v6 offset:20480
    ds_read_b128 v[40:43], v6 offset:30720
    ds_read_b128 v[44:47], v6 offset:40960
    ds_read_b128 v[48:51], v6 offset:51200
    s_waitcnt lgkmcnt(5)
    buffer_store_dwordx4 v[28:31], v3, s[44:47], s60 offen sc1
    s_add_u32 s60, s60, 10240
    s_waitcnt lgkmcnt(4)
    buffer_store_dwordx4 v[32:35], v3, s[44:47], s60 offen sc1
    s_add_u32 s60, s60, 10240
    s_waitcnt lgkmcnt(3)
    buffer_store_dwordx4 v[36:39], v3, s[44:47], s60 offen sc1
    s_add_u32 s60, s60, 10240
    s_waitcnt lgkmcnt(2)
    buffer_store_dwordx4 v[40:43], v3, s[44:47], s60 offen sc1
    s_add_u32 s60, s60, 10240
    s_waitcnt lgkmcnt(1)
    buffer_store_dwordx4 v[44:47], v3, s[44:47], s60 offen sc1
    s_add_u32 s60, s60, 10240
    s_mul_i32 s60, s23, 4
    s_add_u32 s60, s60, 0x1200000
    v_cmp_gt_u32 vcc, 320, v0
    s_and_saveexec_b64 s[54:55], vcc
    s_waitcnt lgkmcnt(0)
    buffer_store_dwordx4 v[48:51], v3, s[44:47], s60 offen sc1
    s_mov_b64 exec, s[54:55]
    s_cmp_eq_u32 s67, 0
    s_cbranch_scc1 K1_END
    s_waitcnt vmcnt(6)
    v_lshl_or_b32 v78, v79, 16, v78
    s_cmp_lg_u32 s2, 36
    s_cbranch_scc1 K1_FRST
    v_cmpx_gt_u32 vcc, 32, v0
K1_FRST:
    buffer_store_dword v78, v1, s[44:47], s62 offen
K1_END:
    s_endpgm
.p2align 8
.type standalone__tensor_product_equiv_mace__graph_kernel,@function
standalone__tensor_product_equiv_mace__graph_kernel:
    s_cmp_ge_u32 s2, 256
    s_cbranch_scc1 K2_END
    s_load_dwordx2 s[4:5], s[0:1], 0
    s_load_dwordx2 s[8:9], s[0:1], 64
    s_load_dwordx2 s[10:11], s[0:1], 80
    s_getpc_b64 s[6:7]
K2_PC:
    s_and_b32 s63, s2, 7
    s_lshr_b32 s62, s2, 3
    s_mul_i32 s3, s63, 31
    s_min_u32 s64, s63, 2
    s_add_u32 s3, s3, s64
    s_add_u32 s3, s3, s62
    s_add_u32 s65, s63, 248
    s_cmp_eq_u32 s62, 31
    s_cselect_b32 s66, s64, 0
    s_cmp_eq_u32 s66, 2
    s_cselect_b32 s3, s65, s3
    v_and_b32 v1, 63, v0
    v_lshrrev_b32 v134, 6, v0
    v_lshlrev_b32 v2, 4, v1
    v_readfirstlane_b32 s54, v134
    v_lshlrev_b32 v136, 2, v1
    v_lshrrev_b32 v134, 1, v1
    v_lshlrev_b32 v134, 10, v134
    s_cmp_ge_u32 s3, 250
    s_cbranch_scc1 K2_PF
    s_lshl_b32 s62, s3, 2
    s_lshl_b32 s63, s54, 15
    s_add_u32 s62, s62, s63
    s_lshl_b32 s63, s54, 6
    s_sub_u32 s63, 500, s63
    v_mov_b32 v162, 0
    v_and_b32 v135, 3, v1
    v_lshlrev_b32 v135, 5, v135
    s_waitcnt lgkmcnt(0)
    s_add_u32 s20, s10, 0x1000000
    s_addc_u32 s21, s11, 0
    s_mov_b32 s22, 0x40000
    s_mov_b32 s23, 0x00020000
    v_cmpx_gt_u32 vcc, s63, v1
    buffer_load_dword v162, v134, s[20:23], s62 offen
    s_mov_b64 exec, -1
    s_add_u32 s24, s10, 0x1100000
    s_addc_u32 s25, s11, 0
    s_mov_b32 s26, 0x9080
    s_mov_b32 s27, 0x00020000
    s_mov_b32 s62, 32768
    buffer_load_dwordx4 v[8:11], v2, s[24:27], s62 offen offset:0
    buffer_load_dwordx4 v[12:15], v2, s[24:27], s62 offen offset:1024
    buffer_load_dwordx4 v[16:19], v2, s[24:27], s62 offen offset:2048
    buffer_load_dwordx4 v[20:23], v2, s[24:27], s62 offen offset:3072
    s_mov_b32 s63, 36864
    buffer_load_dwordx4 v[24:27], v135, s[24:27], s63 offen
    buffer_load_dwordx4 v[28:31], v135, s[24:27], s63 offen offset:16
    s_cmp_lg_u32 s54, 7
    s_cbranch_scc1 K2_NOCPF
    s_sub_u32 s6, s6, K2_PC-standalone__tensor_product_equiv_mace__graph_kernel
    s_subb_u32 s7, s7, 0
    v_lshlrev_b32 v6, 7, v1
    v_cmpx_gt_u32 vcc, K2_CODE_END-standalone__tensor_product_equiv_mace__graph_kernel, v6
    global_load_dword v0, v6, s[6:7]
    v_add_u32 v6, 8192, v6
    v_cmpx_gt_u32 vcc, K2_CODE_END-standalone__tensor_product_equiv_mace__graph_kernel, v6
    global_load_dword v0, v6, s[6:7]
    s_mov_b64 exec, -1
K2_NOCPF:
    s_mov_b32 s16, s10
    s_mov_b32 s17, s11
    s_mov_b32 s18, 0xc35000
    s_mov_b32 s19, 0x00020000
    s_add_u32 s20, s10, 0x1200000
    s_addc_u32 s21, s11, 0
    s_mov_b32 s22, 0x138800
    s_mov_b32 s23, 0x00020000
    s_mov_b32 s12, s4
    s_mov_b32 s13, s5
    s_mov_b32 s14, 0x9c4000
    s_mov_b32 s15, 0x00020000
    s_mov_b32 s28, s8
    s_mov_b32 s29, s9
    s_mov_b32 s30, 0x9c4000
    s_mov_b32 s31, 0x00020000
    v_mov_b32 v3, 1
    s_mov_b32 s40, 0x77777777
    s_mov_b32 s41, 0x77777777
    s_mov_b32 s42, 0x44444444
    s_mov_b32 s43, 0x44444444
    s_mov_b32 s44, 0x11111111
    s_mov_b32 s45, 0x11111111
    s_mov_b32 s46, 0x22222222
    s_mov_b32 s47, 0x22222222
    s_mov_b32 s48, 0x88888888
    s_mov_b32 s49, 0x88888888
    s_mov_b32 s50, 0x0f0f0f0f
    s_mov_b32 s51, 0x0f0f0f0f
    s_mov_b32 s52, 0xf0f0f0f0
    s_mov_b32 s53, 0xf0f0f0f0
    s_mul_i32 s55, s54, 20400
    s_add_u32 s55, s55, 544
    s_add_u32 s61, s55, 32
    s_add_u32 s38, s55, 12208
    s_mov_b32 s69, 224
    s_mov_b32 s58, 0
    v_and_b32 v134, 3, v1
    v_lshrrev_b32 v135, 2, v1
    v_lshlrev_b32 v161, 4, v134
    v_add_u32 v158, 544, v161
    v_lshlrev_b32 v160, 2, v135
    v_add_u32 v160, s55, v160
    v_add_u32 v160, 10800, v160
    v_mov_b32 v135, 0
    s_cmp_lg_u32 s54, 0
    s_cbranch_scc1 K2_NOCNT
    v_cmpx_gt_u32 vcc, 56, v1
    ds_write_b32 v136, v135
    s_mov_b64 exec, -1
K2_NOCNT:
    v_add_u32 v134, s55, v136
    v_mov_b32 v6, 0xffffff
    ds_write_b32 v134, v135 offset:11952
    ds_write_b32 v134, v6 offset:10800
    ds_write_b32 v134, v6 offset:11056
    ds_write_b32 v134, v6 offset:11312
    ds_write_b32 v134, v6 offset:11568
    v_and_b32 v135, 1, v1
    s_waitcnt vmcnt(6)
    v_and_b32 v135, 1, v1
    v_lshrrev_b32 v159, 19, v162
    v_and_b32 v157, 0x7ffff, v162
    v_add_u32 v157, v157, v135
    v_xor_b32 v135, 1, v135
    v_add_u32 v159, v159, v135
    v_lshrrev_b32 v159, 1, v159
    v_mov_b32 v156, v159
    s_nop 1
    v_add_u32_dpp v156, v156, v156 row_shr:1 row_mask:0xf bank_mask:0xf bound_ctrl:0
    s_nop 1
    v_add_u32_dpp v156, v156, v156 row_shr:2 row_mask:0xf bank_mask:0xf bound_ctrl:0
    s_nop 1
    v_add_u32_dpp v156, v156, v156 row_shr:4 row_mask:0xf bank_mask:0xf bound_ctrl:0
    s_nop 1
    v_add_u32_dpp v156, v156, v156 row_shr:8 row_mask:0xf bank_mask:0xf bound_ctrl:0
    s_nop 1
    v_add_u32_dpp v156, v156, v156 row_bcast:15 row_mask:0xa bank_mask:0xf
    s_nop 1
    v_add_u32_dpp v156, v156, v156 row_bcast:31 row_mask:0xc bank_mask:0xf
    s_nop 0
    v_readlane_b32 s57, v156, 63
    v_sub_u32 v156, v156, v159
    s_nop 1
    s_cmp_le_u32 s57, 256
    s_cbranch_scc1 K2_LISTN
    s_mov_b32 s57, 0
    s_mov_b32 s58, 2
K2_LISTN:
    v_lshlrev_b32 v6, 2, v156
    v_add_u32 v6, s55, v6
    v_mov_b32 v7, v159
    v_mov_b32 v4, v157
    s_cmp_eq_u32 s58, 2
    s_cbranch_scc1 K2_L1_DONE
K2_L1:
    v_cmpx_lt_u32 vcc, 0, v7
    ds_write_b32 v6, v4 offset:10800
    v_add_u32 v134, 2, v4
    v_cmpx_lt_u32 vcc, 1, v7
    ds_write_b32 v6, v134 offset:10804
    v_add_u32 v135, 4, v4
    v_cmpx_lt_u32 vcc, 2, v7
    ds_write_b32 v6, v135 offset:10808
    v_add_u32 v134, 6, v4
    v_cmpx_lt_u32 vcc, 3, v7
    ds_write_b32 v6, v134 offset:10812
    v_subrev_u32 v7, 4, v7
    v_add_u32 v4, 8, v4
    v_add_u32 v6, 16, v6
    s_cbranch_execnz K2_L1
    s_mov_b64 exec, -1
K2_L1_DONE:
    s_waitcnt lgkmcnt(0)
    v_add_u32 v134, s55, v136
    ds_read_b32 v72, v134 offset:10800
    ds_read_b32 v73, v134 offset:11056
    ds_read_b32 v74, v134 offset:11312
    ds_read_b32 v75, v134 offset:11568
    ds_read_b32 v104, v160 offset:0
    ds_read_b32 v105, v160 offset:64
    ds_read_b32 v106, v160 offset:128
    ds_read_b32 v107, v160 offset:192
    ds_read_b32 v108, v160 offset:256
    ds_read_b32 v109, v160 offset:320
    ds_read_b32 v110, v160 offset:384
    ds_read_b32 v111, v160 offset:448
    ds_read_b32 v112, v160 offset:512
    ds_read_b32 v113, v160 offset:576
    ds_read_b32 v114, v160 offset:640
    ds_read_b32 v115, v160 offset:704
    ds_read_b32 v116, v160 offset:768
    ds_read_b32 v117, v160 offset:832
    ds_read_b32 v118, v160 offset:896
    ds_read_b32 v119, v160 offset:960
    s_waitcnt lgkmcnt(15)
    v_lshlrev_b32 v72, 2, v72
    buffer_load_dword v76, v72, s[20:23], 0 offen
    v_lshlrev_b32 v73, 2, v73
    buffer_load_dword v77, v73, s[20:23], 0 offen
    v_lshlrev_b32 v74, 2, v74
    buffer_load_dword v78, v74, s[20:23], 0 offen
    v_lshlrev_b32 v75, 2, v75
    buffer_load_dword v79, v75, s[20:23], 0 offen
    s_waitcnt lgkmcnt(0)
    s_mov_b64 exec, s[40:41]
    v_mad_u32_u24 v104, v104, 40, v161
    buffer_load_dwordx4 v[192:195], v104, s[16:19], 0 offen
    v_mad_u32_u24 v105, v105, 40, v161
    buffer_load_dwordx4 v[196:199], v105, s[16:19], 0 offen
    v_mad_u32_u24 v106, v106, 40, v161
    buffer_load_dwordx4 v[200:203], v106, s[16:19], 0 offen
    s_mov_b64 exec, -1
    v_mov_b32 v32, 0
    v_mov_b32 v33, 0
    v_mov_b32 v34, 0
    v_mov_b32 v35, 0
    v_mov_b32 v36, 0
    v_mov_b32 v37, 0
    v_mov_b32 v38, 0
    v_mov_b32 v39, 0
    v_mov_b32 v40, 0
    v_mov_b32 v41, 0
    v_mov_b32 v42, 0
    v_mov_b32 v43, 0
    v_mov_b32 v44, 0
    v_mov_b32 v45, 0
    v_mov_b32 v46, 0
    v_mov_b32 v47, 0
    v_mov_b32 v48, 0
    v_mov_b32 v49, 0
    v_mov_b32 v50, 0
    v_mov_b32 v51, 0
    v_mov_b32 v52, 0
    v_mov_b32 v53, 0
    v_mov_b32 v54, 0
    v_mov_b32 v55, 0
    v_mov_b32 v56, 0
    v_mov_b32 v57, 0
    v_mov_b32 v58, 0
    v_mov_b32 v59, 0
    v_mov_b32 v60, 0
    v_mov_b32 v61, 0
    v_mov_b32 v62, 0
    v_mov_b32 v63, 0
    v_mov_b32 v64, 0
    v_mov_b32 v65, 0
    v_mov_b32 v66, 0
    v_mov_b32 v67, 0
    v_mov_b32 v68, 0
    v_mov_b32 v69, 0
    v_mov_b32 v70, 0
    v_mov_b32 v71, 0
    v_mov_b32 v140, 0
    v_mov_b32 v141, 0
    v_mov_b32 v142, 0
    v_mov_b32 v143, 0
    v_mov_b32 v144, 0
    v_mov_b32 v145, 0
    v_mov_b32 v146, 0
    v_mov_b32 v147, 0
    v_mov_b32 v148, 0
    v_mov_b32 v149, 0
    v_mov_b32 v150, 0
    v_mov_b32 v151, 0
    v_mov_b32 v152, 0
    v_mov_b32 v153, 0
    v_mov_b32 v154, 0
    v_mov_b32 v155, 0
    v_lshrrev_b32 v133, 5, v1
    v_lshlrev_b32 v133, 4, v133
    v_add_u32 v133, s55, v133
    v_lshrrev_b32 v134, 4, v1
    v_and_b32 v135, 15, v1
    v_lshlrev_b32 v137, 2, v134
    v_sub_u32 v137, v135, v137
    v_and_b32 v137, 15, v137
    v_lshlrev_b32 v137, 4, v137
    v_lshl_add_u32 v137, v134, 8, v137
    v_bfe_u32 v6, v1, 2, 2
    v_bfe_u32 v7, v1, 1, 1
    v_lshl_add_u32 v7, v134, 1, v7
    v_lshl_add_u32 v7, v6, 2, v7
    v_and_b32 v138, 15, v7
    v_add_u32 v139, 8, v7
    v_and_b32 v139, 15, v139
    v_and_b32 v7, 1, v1
    v_lshlrev_b32 v7, 3, v7
    v_lshl_add_u32 v7, v6, 8, v7
    v_add_u32 v7, s38, v7
    v_lshl_add_u32 v138, v138, 4, v7
    v_lshl_add_u32 v139, v139, 4, v7
    s_mov_b32 s65, 0x80fffc00
    s_waitcnt vmcnt(3)
    s_barrier
    s_cmp_lg_u32 s58, 2
    s_cbranch_scc1 K2_NOFLAG
    v_mov_b32 v134, 48
    v_mov_b32 v135, 0xffff
    ds_write_b32 v134, v135
K2_NOFLAG:
    v_cmpx_gt_i32 vcc, 0, v76
    v_and_b32 v80, 0xfc, v76
    ds_add_u32 v80, v3 offset:64
    s_mov_b64 exec, -1
    v_cmpx_gt_i32 vcc, 0, v77
    v_and_b32 v81, 0xfc, v77
    ds_add_u32 v81, v3 offset:64
    s_mov_b64 exec, -1
    v_cmpx_gt_i32 vcc, 0, v78
    v_and_b32 v82, 0xfc, v78
    ds_add_u32 v82, v3 offset:64
    s_mov_b64 exec, -1
    v_cmpx_gt_i32 vcc, 0, v79
    v_and_b32 v83, 0xfc, v79
    ds_add_u32 v83, v3 offset:64
    s_mov_b64 exec, -1
    s_mov_b64 exec, s[40:41]
    v_mad_u32_u24 v107, v107, 40, v161
    buffer_load_dwordx4 v[204:207], v107, s[16:19], 0 offen
    v_mad_u32_u24 v108, v108, 40, v161
    buffer_load_dwordx4 v[208:211], v108, s[16:19], 0 offen
    v_mad_u32_u24 v109, v109, 40, v161
    buffer_load_dwordx4 v[212:215], v109, s[16:19], 0 offen
    s_mov_b64 exec, -1
    s_waitcnt lgkmcnt(0)
    s_barrier
    s_cmp_eq_u32 s54, 0
    s_cbranch_scc1 K2_MAP
    s_mov_b64 exec, s[40:41]
    v_mad_u32_u24 v110, v110, 40, v161
    buffer_load_dwordx4 v[216:219], v110, s[16:19], 0 offen
    v_mad_u32_u24 v111, v111, 40, v161
    buffer_load_dwordx4 v[220:223], v111, s[16:19], 0 offen
    v_mad_u32_u24 v112, v112, 40, v161
    buffer_load_dwordx4 v[224:227], v112, s[16:19], 0 offen
    s_cmp_le_u32 s57, 144
    s_cbranch_scc1 K2_LD_DONE
    v_mad_u32_u24 v113, v113, 40, v161
    buffer_load_dwordx4 v[228:231], v113, s[16:19], 0 offen
    s_cmp_le_u32 s57, 160
    s_cbranch_scc1 K2_LD_DONE
    v_mad_u32_u24 v114, v114, 40, v161
    buffer_load_dwordx4 v[232:235], v114, s[16:19], 0 offen
    s_cmp_le_u32 s57, 176
    s_cbranch_scc1 K2_LD_DONE
    v_mad_u32_u24 v115, v115, 40, v161
    buffer_load_dwordx4 v[236:239], v115, s[16:19], 0 offen
    s_cmp_le_u32 s57, 192
    s_cbranch_scc1 K2_LD_DONE
    v_mad_u32_u24 v116, v116, 40, v161
    buffer_load_dwordx4 v[240:243], v116, s[16:19], 0 offen
    s_cmp_le_u32 s57, 208
    s_cbranch_scc1 K2_LD_DONE
    v_mad_u32_u24 v117, v117, 40, v161
    buffer_load_dwordx4 v[244:247], v117, s[16:19], 0 offen
    s_cmp_le_u32 s57, 224
    s_cbranch_scc1 K2_LD_DONE
    v_mad_u32_u24 v118, v118, 40, v161
    buffer_load_dwordx4 v[248:251], v118, s[16:19], 0 offen
    s_cmp_le_u32 s57, 240
    s_cbranch_scc1 K2_LD_DONE
    v_mad_u32_u24 v119, v119, 40, v161
    buffer_load_dwordx4 v[252:255], v119, s[16:19], 0 offen
K2_LD_DONE:
    s_mov_b64 exec, -1
    s_branch K2_MAP_DONE
K2_MAP:
    v_cmpx_gt_u32 vcc, 40, v1
    ds_read_b32 v6, v136 offset:64
    s_add_u32 s64, s55, 11952
    s_waitcnt lgkmcnt(0)
    v_min_u32 v6, 63, v6
    v_lshl_add_u32 v6, v6, 2, s64
    ds_add_rtn_u32 v7, v6, v3
    s_mov_b64 exec, -1
    v_add_u32 v134, s64, v136
    ds_read_b32 v4, v134
    s_waitcnt lgkmcnt(0)
    v_mov_b32 v5, v4
    s_nop 1
    v_add_u32_dpp v5, v5, v5 row_shr:1 row_mask:0xf bank_mask:0xf bound_ctrl:0
    s_nop 1
    v_add_u32_dpp v5, v5, v5 row_shr:2 row_mask:0xf bank_mask:0xf bound_ctrl:0
    s_nop 1
    v_add_u32_dpp v5, v5, v5 row_shr:4 row_mask:0xf bank_mask:0xf bound_ctrl:0
    s_nop 1
    v_add_u32_dpp v5, v5, v5 row_shr:8 row_mask:0xf bank_mask:0xf bound_ctrl:0
    s_nop 1
    v_add_u32_dpp v5, v5, v5 row_bcast:15 row_mask:0xa bank_mask:0xf
    s_nop 1
    v_add_u32_dpp v5, v5, v5 row_bcast:31 row_mask:0xc bank_mask:0xf
    v_sub_u32 v5, v5, v4
    ds_write_b32 v134, v5
    v_cmpx_gt_u32 vcc, 40, v1
    ds_read_b32 v4, v6
    s_waitcnt lgkmcnt(0)
    v_add_u32 v4, v4, v7
    v_lshrrev_b32 v7, 3, v4
    v_and_b32 v6, 7, v4
    v_and_b32 v135, 1, v7
    v_mul_u32_u24 v135, 7, v135
    v_xor_b32 v6, v6, v135
    v_lshlrev_b32 v4, 5, v7
    v_lshl_or_b32 v4, v6, 2, v4
    ds_write_b32 v136, v4 offset:224
    v_mul_u32_u24 v6, 5, v6
    v_add_u32 v6, v6, v7
    v_lshlrev_b32 v6, 2, v6
    v_lshlrev_b32 v4, 10, v1
    ds_write_b32 v6, v4 offset:384
    s_mov_b64 exec, -1
    v_mov_b32 v4, 0
    ds_write_b32 v134, v4
    s_waitcnt lgkmcnt(0)
K2_MAP_DONE:
    s_barrier
    s_cmp_lg_u32 s54, 0
    s_cbranch_scc1 K2_PL0_DONE
    s_mov_b64 exec, s[40:41]
    v_mad_u32_u24 v110, v110, 40, v161
    buffer_load_dwordx4 v[216:219], v110, s[16:19], 0 offen
    v_mad_u32_u24 v111, v111, 40, v161
    buffer_load_dwordx4 v[220:223], v111, s[16:19], 0 offen
    v_mad_u32_u24 v112, v112, 40, v161
    buffer_load_dwordx4 v[224:227], v112, s[16:19], 0 offen
    s_cmp_le_u32 s57, 144
    s_cbranch_scc1 K2_LD_DONE0
    v_mad_u32_u24 v113, v113, 40, v161
    buffer_load_dwordx4 v[228:231], v113, s[16:19], 0 offen
    s_cmp_le_u32 s57, 160
    s_cbranch_scc1 K2_LD_DONE0
    v_mad_u32_u24 v114, v114, 40, v161
    buffer_load_dwordx4 v[232:235], v114, s[16:19], 0 offen
    s_cmp_le_u32 s57, 176
    s_cbranch_scc1 K2_LD_DONE0
    v_mad_u32_u24 v115, v115, 40, v161
    buffer_load_dwordx4 v[236:239], v115, s[16:19], 0 offen
    s_cmp_le_u32 s57, 192
    s_cbranch_scc1 K2_LD_DONE0
    v_mad_u32_u24 v116, v116, 40, v161
    buffer_load_dwordx4 v[240:243], v116, s[16:19], 0 offen
    s_cmp_le_u32 s57, 208
    s_cbranch_scc1 K2_LD_DONE0
    v_mad_u32_u24 v117, v117, 40, v161
    buffer_load_dwordx4 v[244:247], v117, s[16:19], 0 offen
    s_cmp_le_u32 s57, 224
    s_cbranch_scc1 K2_LD_DONE0
    v_mad_u32_u24 v118, v118, 40, v161
    buffer_load_dwordx4 v[248:251], v118, s[16:19], 0 offen
    s_cmp_le_u32 s57, 240
    s_cbranch_scc1 K2_LD_DONE0
    v_mad_u32_u24 v119, v119, 40, v161
    buffer_load_dwordx4 v[252:255], v119, s[16:19], 0 offen
K2_LD_DONE0:
    s_mov_b64 exec, -1
K2_PL0_DONE:
    v_and_b32 v80, 0xfc, v76
    ds_read_b32 v80, v80 offset:224
    v_and_b32 v81, 0xfc, v77
    ds_read_b32 v81, v81 offset:224
    v_and_b32 v82, 0xfc, v78
    ds_read_b32 v82, v82 offset:224
    v_and_b32 v83, 0xfc, v79
    ds_read_b32 v83, v83 offset:224
    s_add_u32 s64, s55, 10752
    v_mov_b32 v6, s64
    v_add_u32 v7, s38, v136
    s_movk_i32 s66, 544
    s_mov_b32 s67, 12752
    s_waitcnt lgkmcnt(0)
    v_and_or_b32 v76, v76, s65, v80
    v_and_b32 v80, 0x1c, v80
    v_cmpx_gt_i32 vcc, 0, v76
    ds_add_rtn_u32 v84, v80, v3
    s_mov_b64 exec, -1
    v_and_or_b32 v77, v77, s65, v81
    v_and_b32 v81, 0x1c, v81
    v_cmpx_gt_i32 vcc, 0, v77
    ds_add_rtn_u32 v85, v81, v3
    s_mov_b64 exec, -1
    v_and_or_b32 v78, v78, s65, v82
    v_and_b32 v82, 0x1c, v82
    v_cmpx_gt_i32 vcc, 0, v78
    ds_add_rtn_u32 v86, v82, v3
    s_mov_b64 exec, -1
    v_and_or_b32 v79, v79, s65, v83
    v_and_b32 v83, 0x1c, v83
    v_cmpx_gt_i32 vcc, 0, v79
    ds_add_rtn_u32 v87, v83, v3
    s_mov_b64 exec, -1
    v_mul_u32_u24 v80, 5100, v80
    v_mul_u32_u24 v81, 5100, v81
    v_mul_u32_u24 v82, 5100, v82
    v_mul_u32_u24 v83, 5100, v83
    s_waitcnt lgkmcnt(0)
    v_cmp_gt_i32 vcc, 0, v76
    v_min_u32 v84, s69, v84
    v_lshl_add_u32 v135, v84, 2, v80
    v_mad_u32_u24 v134, v84, 48, v80
    v_add_u32 v135, s67, v135
    v_add_u32 v134, s66, v134
    v_cndmask_b32 v134, v6, v134, vcc
    ds_write_b32 v7, v134 offset:1024
    s_mov_b64 exec, vcc
    ds_write_b32 v135, v76
    s_mov_b64 exec, -1
    v_cmp_gt_i32 vcc, 0, v77
    v_min_u32 v85, s69, v85
    v_lshl_add_u32 v135, v85, 2, v81
    v_mad_u32_u24 v134, v85, 48, v81
    v_add_u32 v135, s67, v135
    v_add_u32 v134, s66, v134
    v_cndmask_b32 v134, v6, v134, vcc
    ds_write_b32 v7, v134 offset:1280
    s_mov_b64 exec, vcc
    ds_write_b32 v135, v77
    s_mov_b64 exec, -1
    v_cmp_gt_i32 vcc, 0, v78
    v_min_u32 v86, s69, v86
    v_lshl_add_u32 v135, v86, 2, v82
    v_mad_u32_u24 v134, v86, 48, v82
    v_add_u32 v135, s67, v135
    v_add_u32 v134, s66, v134
    v_cndmask_b32 v134, v6, v134, vcc
    ds_write_b32 v7, v134 offset:1536
    s_mov_b64 exec, vcc
    ds_write_b32 v135, v78
    s_mov_b64 exec, -1
    v_cmp_gt_i32 vcc, 0, v79
    v_min_u32 v87, s69, v87
    v_lshl_add_u32 v135, v87, 2, v83
    v_mad_u32_u24 v134, v87, 48, v83
    v_add_u32 v135, s67, v135
    v_add_u32 v134, s66, v134
    v_cndmask_b32 v134, v6, v134, vcc
    ds_write_b32 v7, v134 offset:1792
    s_mov_b64 exec, vcc
    ds_write_b32 v135, v79
    s_mov_b64 exec, -1
    s_waitcnt lgkmcnt(0)
    s_barrier
K2_AFTER:
    v_and_b32 v134, 63, v136
    ds_read_b32 v135, v134
    v_add_u32 v134, s55, v136
    v_add_u32 v6, s38, v136
    ds_read_b32 v72, v6 offset:0
    ds_read_b32 v73, v6 offset:256
    ds_read_b32 v74, v6 offset:512
    ds_read_b32 v75, v6 offset:768
    v_mov_b32 v7, 0
    ds_write_b32 v134, v7 offset:10800
    ds_write_b32 v134, v7 offset:11056
    ds_write_b32 v134, v7 offset:11312
    ds_write_b32 v134, v7 offset:11568
    v_cmpx_gt_u32 vcc, 32, v1
    ds_write_b32 v134, v7 offset:11824
    s_mov_b64 exec, -1
    s_add_u32 s64, s55, 11952
    s_waitcnt lgkmcnt(5)
    v_readlane_b32 s56, v135, s54
    s_cmp_eq_u32 s58, 1
    s_cbranch_scc1 K2_SORT
    v_cmp_lt_u32 vcc, s69, v135
    s_cbranch_vccnz K2_SLOW_INIT
K2_SORT:
    s_sub_i32 s62, s56, 0
    s_max_i32 s62, s62, 0
    v_cmp_gt_u32 s[86:87], s62, v1
    v_bfe_u32 v76, v72, 18, 6
    v_lshl_add_u32 v76, v76, 2, s64
    s_sub_i32 s62, s56, 64
    s_max_i32 s62, s62, 0
    v_cmp_gt_u32 s[88:89], s62, v1
    v_bfe_u32 v77, v73, 18, 6
    v_lshl_add_u32 v77, v77, 2, s64
    s_sub_i32 s62, s56, 128
    s_max_i32 s62, s62, 0
    v_cmp_gt_u32 s[90:91], s62, v1
    v_bfe_u32 v78, v74, 18, 6
    v_lshl_add_u32 v78, v78, 2, s64
    s_sub_i32 s62, s56, 192
    s_max_i32 s62, s62, 0
    v_cmp_gt_u32 s[92:93], s62, v1
    v_bfe_u32 v79, v75, 18, 6
    v_lshl_add_u32 v79, v79, 2, s64
    s_mov_b64 exec, s[86:87]
    ds_add_rtn_u32 v80, v76, v3
    s_mov_b64 exec, s[88:89]
    ds_add_rtn_u32 v81, v77, v3
    s_mov_b64 exec, s[90:91]
    ds_add_rtn_u32 v82, v78, v3
    s_mov_b64 exec, s[92:93]
    ds_add_rtn_u32 v83, v79, v3
    s_mov_b64 exec, -1
    ds_read_b32 v7, v134 offset:11952
    s_mov_b32 s65, 0xfffc38
    v_and_b32 v88, 0xfffc00, v72
    v_lshrrev_b32 v135, 2, v72
    v_and_or_b32 v88, v135, 56, v88
    v_add_u32 v135, 0, v1
    v_lshl_or_b32 v88, v135, 24, v88
    v_and_b32 v89, 0xfffc00, v73
    v_lshrrev_b32 v135, 2, v73
    v_and_or_b32 v89, v135, 56, v89
    v_add_u32 v135, 64, v1
    v_lshl_or_b32 v89, v135, 24, v89
    v_and_b32 v90, 0xfffc00, v74
    v_lshrrev_b32 v135, 2, v74
    v_and_or_b32 v90, v135, 56, v90
    v_add_u32 v135, 128, v1
    v_lshl_or_b32 v90, v135, 24, v90
    v_and_b32 v91, 0xfffc00, v75
    v_lshrrev_b32 v135, 2, v75
    v_and_or_b32 v91, v135, 56, v91
    v_add_u32 v135, 192, v1
    v_lshl_or_b32 v91, v135, 24, v91
    s_waitcnt lgkmcnt(0)
    v_mov_b32 v4, v7
    s_nop 1
    v_add_u32_dpp v4, v4, v4 row_shr:1 row_mask:0xf bank_mask:0xf bound_ctrl:0
    s_nop 1
    v_add_u32_dpp v4, v4, v4 row_shr:2 row_mask:0xf bank_mask:0xf bound_ctrl:0
    s_nop 1
    v_add_u32_dpp v4, v4, v4 row_shr:4 row_mask:0xf bank_mask:0xf bound_ctrl:0
    s_nop 1
    v_add_u32_dpp v4, v4, v4 row_shr:8 row_mask:0xf bank_mask:0xf bound_ctrl:0
    s_nop 1
    v_add_u32_dpp v4, v4, v4 row_bcast:15 row_mask:0xa bank_mask:0xf
    s_nop 1
    v_add_u32_dpp v4, v4, v4 row_bcast:31 row_mask:0xc bank_mask:0xf
    v_sub_u32 v4, v4, v7
    ds_write_b32 v134, v4 offset:11952
    ds_read_b32 v84, v76
    ds_read_b32 v85, v77
    ds_read_b32 v86, v78
    ds_read_b32 v87, v79
    s_add_u32 s64, s55, 10800
    v_and_b32 v134, 31, v1
    v_lshlrev_b32 v132, 2, v134
    v_add_u32 v132, s64, v132
    v_lshrrev_b32 v135, 3, v134
    v_lshlrev_b32 v135, 2, v135
    v_and_or_b32 v135, v134, 3, v135
    v_lshlrev_b32 v130, 2, v135
    v_add_u32 v130, s64, v130
    v_lshrrev_b32 v134, 2, v1
    v_lshlrev_b32 v131, 2, v134
    v_add_u32 v131, s64, v131
    s_waitcnt lgkmcnt(0)
    v_add_u32 v84, v84, v80
    v_lshl_add_u32 v84, v84, 2, s64
    s_mov_b64 exec, s[86:87]
    ds_write_b32 v84, v88
    s_mov_b64 exec, -1
    v_add_u32 v85, v85, v81
    v_lshl_add_u32 v85, v85, 2, s64
    s_mov_b64 exec, s[88:89]
    ds_write_b32 v85, v89
    s_mov_b64 exec, -1
    v_add_u32 v86, v86, v82
    v_lshl_add_u32 v86, v86, 2, s64
    s_mov_b64 exec, s[90:91]
    ds_write_b32 v86, v90
    s_mov_b64 exec, -1
    v_add_u32 v87, v87, v83
    v_lshl_add_u32 v87, v87, 2, s64
    s_mov_b64 exec, s[92:93]
    ds_write_b32 v87, v91
    s_mov_b64 exec, -1
    s_cmp_eq_u32 s58, 1
    s_cbranch_scc1 K2_MAIN_SETUP
    v_lshrrev_b32 v134, 2, v1
    v_lshlrev_b32 v134, 2, v134
    v_add_u32 v134, s38, v134
    ds_read_b32 v104, v134 offset:1024
    ds_read_b32 v105, v134 offset:1088
    ds_read_b32 v106, v134 offset:1152
    ds_read_b32 v107, v134 offset:1216
    ds_read_b32 v108, v134 offset:1280
    ds_read_b32 v109, v134 offset:1344
    ds_read_b32 v110, v134 offset:1408
    ds_read_b32 v111, v134 offset:1472
    ds_read_b32 v112, v134 offset:1536
    ds_read_b32 v113, v134 offset:1600
    ds_read_b32 v114, v134 offset:1664
    ds_read_b32 v115, v134 offset:1728
    ds_read_b32 v116, v134 offset:1792
    ds_read_b32 v117, v134 offset:1856
    ds_read_b32 v118, v134 offset:1920
    ds_read_b32 v119, v134 offset:1984
    s_mov_b64 exec, s[40:41]
    s_waitcnt vmcnt(0) lgkmcnt(0)
    v_add_u32 v104, v104, v161
    ds_write_b128 v104, v[192:195]
    v_add_u32 v105, v105, v161
    ds_write_b128 v105, v[196:199]
    v_add_u32 v106, v106, v161
    ds_write_b128 v106, v[200:203]
    v_add_u32 v107, v107, v161
    ds_write_b128 v107, v[204:207]
    v_add_u32 v108, v108, v161
    ds_write_b128 v108, v[208:211]
    v_add_u32 v109, v109, v161
    ds_write_b128 v109, v[212:215]
    v_add_u32 v110, v110, v161
    ds_write_b128 v110, v[216:219]
    v_add_u32 v111, v111, v161
    ds_write_b128 v111, v[220:223]
    v_add_u32 v112, v112, v161
    ds_write_b128 v112, v[224:227]
    s_cmp_le_u32 s57, 144
    s_cbranch_scc1 K2_P2_DONE
    v_add_u32 v113, v113, v161
    ds_write_b128 v113, v[228:231]
    s_cmp_le_u32 s57, 160
    s_cbranch_scc1 K2_P2_DONE
    v_add_u32 v114, v114, v161
    ds_write_b128 v114, v[232:235]
    s_cmp_le_u32 s57, 176
    s_cbranch_scc1 K2_P2_DONE
    v_add_u32 v115, v115, v161
    ds_write_b128 v115, v[236:239]
    s_cmp_le_u32 s57, 192
    s_cbranch_scc1 K2_P2_DONE
    v_add_u32 v116, v116, v161
    ds_write_b128 v116, v[240:243]
    s_cmp_le_u32 s57, 208
    s_cbranch_scc1 K2_P2_DONE
    v_add_u32 v117, v117, v161
    ds_write_b128 v117, v[244:247]
    s_cmp_le_u32 s57, 224
    s_cbranch_scc1 K2_P2_DONE
    v_add_u32 v118, v118, v161
    ds_write_b128 v118, v[248:251]
    s_cmp_le_u32 s57, 240
    s_cbranch_scc1 K2_P2_DONE
    v_add_u32 v119, v119, v161
    ds_write_b128 v119, v[252:255]
K2_P2_DONE:
    s_mov_b64 exec, -1
    s_and_b32 s62, s54, 3
    s_lshl_b32 s62, s62, 13
    s_add_u32 s63, s62, 4096
    s_waitcnt lgkmcnt(0)
    buffer_load_dwordx4 v[164:167], v2, s[24:27], s62 offen offset:0
    buffer_load_dwordx4 v[168:171], v2, s[24:27], s62 offen offset:1024
    buffer_load_dwordx4 v[172:175], v2, s[24:27], s62 offen offset:2048
    buffer_load_dwordx4 v[176:179], v2, s[24:27], s62 offen offset:3072
    buffer_load_dwordx4 v[180:183], v2, s[24:27], s63 offen offset:0
    buffer_load_dwordx4 v[184:187], v2, s[24:27], s63 offen offset:1024
    buffer_load_dwordx4 v[188:191], v2, s[24:27], s63 offen offset:2048
    buffer_load_dwordx4 v[192:195], v2, s[24:27], s63 offen offset:3072
    s_barrier
K2_MAIN_SETUP:
    s_cmp_eq_u32 s56, 0
    s_cbranch_scc1 K2_EMPTY
    ds_read_b32 v4, v132
    ds_read_b32 v6, v130
    ds_read_b32 v7, v131
    s_mov_b32 s68, s56
    s_mov_b32 s65, 0xfffc00
    s_waitcnt lgkmcnt(0)
    v_readlane_b32 s70, v4, 0
    v_readlane_b32 s71, v4, 1
    v_readlane_b32 s72, v4, 2
    v_readlane_b32 s73, v4, 3
    v_readlane_b32 s74, v4, 4
    v_readlane_b32 s75, v4, 5
    v_readlane_b32 s76, v4, 6
    v_readlane_b32 s77, v4, 7
    v_readlane_b32 s78, v4, 8
    s_nop 3
    s_add_u32 m0, s38, 0
    s_and_b32 s66, s70, s65
    buffer_load_dwordx4 v137, s[12:15], s66 offen lds
    s_add_u32 m0, s38, 1024
    s_and_b32 s66, s71, s65
    buffer_load_dwordx4 v137, s[12:15], s66 offen lds
    s_add_u32 m0, s38, 2048
    s_and_b32 s66, s72, s65
    buffer_load_dwordx4 v137, s[12:15], s66 offen lds
    s_add_u32 m0, s38, 3072
    s_and_b32 s66, s73, s65
    buffer_load_dwordx4 v137, s[12:15], s66 offen lds
    s_add_u32 m0, s38, 4096
    s_and_b32 s66, s74, s65
    buffer_load_dwordx4 v137, s[12:15], s66 offen lds
    s_add_u32 m0, s38, 5120
    s_and_b32 s66, s75, s65
    buffer_load_dwordx4 v137, s[12:15], s66 offen lds
    s_add_u32 m0, s38, 6144
    s_and_b32 s66, s76, s65
    buffer_load_dwordx4 v137, s[12:15], s66 offen lds
    s_add_u32 m0, s38, 7168
    s_and_b32 s66, s77, s65
    buffer_load_dwordx4 v137, s[12:15], s66 offen lds
    v_lshrrev_b32 v134, 24, v6
    v_lshrrev_b32 v135, 24, v7
    v_mad_u32_u24 v134, v134, 48, v133
    v_mad_u32_u24 v135, v135, 48, s61
    s_mov_b64 exec, s[50:51]
    ds_read_b128 v[140:143], v134
    s_mov_b64 exec, s[52:53]
    ds_read_b128 v[144:147], v134
    s_mov_b64 exec, s[44:45]
    ds_read_b64 v[148:149], v135
    s_mov_b64 exec, s[46:47]
    ds_read_b64 v[150:151], v135
    s_mov_b64 exec, s[42:43]
    ds_read_b64 v[152:153], v135
    s_mov_b64 exec, s[48:49]
    ds_read_b64 v[154:155], v135
    s_mov_b64 exec, -1
    v_and_b32 v109, 15, v1
    v_lshrrev_b32 v104, 4, v1
    s_lshr_b32 s62, s54, 2
    s_mul_i32 s62, s62, 80
    v_add_u32 v105, s62, v109
    s_movk_i32 s67, 272
    v_lshlrev_b32 v106, 4, v104
    v_add_u32 v107, 544, v106
    v_add_u32 v108, 0, v105
    v_and_b32 v109, 0xfc, v108
    ds_read_b32 v201, v109 offset:384
    v_mul_u32_u24 v109, 3277, v108
    v_lshrrev_b32 v109, 16, v109
    v_mul_u32_u24 v109, 14960, v109
    v_mad_u32_u24 v196, v108, s67, v109
    v_add_u32 v196, v196, v107
    v_add_u32 v108, 16, v105
    v_and_b32 v109, 0xfc, v108
    ds_read_b32 v202, v109 offset:384
    v_mul_u32_u24 v109, 3277, v108
    v_lshrrev_b32 v109, 16, v109
    v_mul_u32_u24 v109, 14960, v109
    v_mad_u32_u24 v197, v108, s67, v109
    v_add_u32 v197, v197, v107
    v_add_u32 v108, 32, v105
    v_and_b32 v109, 0xfc, v108
    ds_read_b32 v203, v109 offset:384
    v_mul_u32_u24 v109, 3277, v108
    v_lshrrev_b32 v109, 16, v109
    v_mul_u32_u24 v109, 14960, v109
    v_mad_u32_u24 v198, v108, s67, v109
    v_add_u32 v198, v198, v107
    v_add_u32 v108, 48, v105
    v_and_b32 v109, 0xfc, v108
    ds_read_b32 v204, v109 offset:384
    v_mul_u32_u24 v109, 3277, v108
    v_lshrrev_b32 v109, 16, v109
    v_mul_u32_u24 v109, 14960, v109
    v_mad_u32_u24 v199, v108, s67, v109
    v_add_u32 v199, v199, v107
    v_add_u32 v108, 64, v105
    v_and_b32 v109, 0xfc, v108
    ds_read_b32 v205, v109 offset:384
    v_mul_u32_u24 v109, 3277, v108
    v_lshrrev_b32 v109, 16, v109
    v_mul_u32_u24 v109, 14960, v109
    v_mad_u32_u24 v200, v108, s67, v109
    v_add_u32 v200, v200, v107
    v_and_b32 v108, 3, v1
    v_lshl_add_u32 v106, v108, 8, v106
    s_waitcnt lgkmcnt(0)
    v_add_u32 v201, v201, v106
    v_add_u32 v202, v202, v106
    v_add_u32 v203, v203, v106
    v_add_u32 v204, v204, v106
    v_add_u32 v205, v205, v106
    s_waitcnt vmcnt(7)
    ds_read_b64_tr_b16 v[120:121], v138 offset:0
    ds_read_b64_tr_b16 v[122:123], v139 offset:0
    s_waitcnt vmcnt(6)
    ds_read_b64_tr_b16 v[124:125], v138 offset:1024
    ds_read_b64_tr_b16 v[126:127], v139 offset:1024
K2_LOOP:
    s_cmp_lt_u32 s68, 17
    s_cbranch_scc1 K2_TAIL
    s_waitcnt lgkmcnt(0)
    v_mfma_f32_4x4x4_16b_bf16 v[104:107], v[24:25], v[148:149], 0
    v_mfma_f32_32x32x16_bf16 v[72:87], v[140:143], v[8:11], 0
    v_add_u32 v132, 64, v132
    v_mfma_f32_4x4x4_16b_bf16 v[104:107], v[26:27], v[150:151], v[104:107]
    v_mfma_f32_32x32x16_bf16 v[88:103], v[140:143], v[16:19], 0
    v_add_u32 v130, 64, v130
    v_mfma_f32_4x4x4_16b_bf16 v[104:107], v[28:29], v[152:153], v[104:107]
    v_mfma_f32_32x32x16_bf16 v[72:87], v[144:147], v[12:15], v[72:87]
    v_add_u32 v131, 64, v131
    v_mfma_f32_4x4x4_16b_bf16 v[104:107], v[30:31], v[154:155], v[104:107]
    v_mfma_f32_32x32x16_bf16 v[88:103], v[144:147], v[20:23], v[88:103]
    ds_read_b32 v5, v132
    ds_read_b32 v6, v130
    ds_read_b32 v7, v131
    s_nop 1
    v_cvt_pk_bf16_f32 v128, v104, v105
    v_cvt_pk_bf16_f32 v129, v106, v107
    s_nop 1
    v_mfma_f32_4x4x4_16b_bf16 v[104:107], v[128:129], v[120:121], 0 cbsz:4 abid:0
    v_mfma_f32_4x4x4_16b_bf16 v[108:111], v[128:129], v[122:123], 0 cbsz:4 abid:0
    v_readlane_b32 s79, v4, 9
    s_add_u32 m0, s38, 0
    s_and_b32 s66, s78, s65
    buffer_load_dwordx4 v137, s[12:15], s66 offen lds
    s_waitcnt vmcnt(6)
    ds_read_b64_tr_b16 v[120:121], v138 offset:2048
    ds_read_b64_tr_b16 v[122:123], v139 offset:2048
    s_and_b32 s67, s70, 0x38
    s_waitcnt lgkmcnt(2)
    v_mfma_f32_4x4x4_16b_bf16 v[112:115], v[128:129], v[124:125], 0 cbsz:4 abid:1
    v_mfma_f32_4x4x4_16b_bf16 v[116:119], v[128:129], v[126:127], 0 cbsz:4 abid:1
    s_set_gpr_idx_on s67, gpr_idx(SRC2,DST)
    v_pk_fma_f32 v[32:33], v[104:105], v[72:73], v[32:33] op_sel:[0,0,0] op_sel_hi:[1,0,1]
    v_pk_fma_f32 v[34:35], v[106:107], v[72:73], v[34:35] op_sel:[0,0,0] op_sel_hi:[1,0,1]
    v_pk_fma_f32 v[36:37], v[108:109], v[88:89], v[36:37] op_sel:[0,0,0] op_sel_hi:[1,0,1]
    v_pk_fma_f32 v[38:39], v[110:111], v[88:89], v[38:39] op_sel:[0,0,0] op_sel_hi:[1,0,1]
    s_set_gpr_idx_off
    v_readlane_b32 s80, v4, 10
    s_add_u32 m0, s38, 1024
    s_and_b32 s66, s79, s65
    buffer_load_dwordx4 v137, s[12:15], s66 offen lds
    s_waitcnt vmcnt(6)
    ds_read_b64_tr_b16 v[124:125], v138 offset:3072
    ds_read_b64_tr_b16 v[126:127], v139 offset:3072
    s_and_b32 s67, s71, 0x38
    s_waitcnt lgkmcnt(2)
    v_mfma_f32_4x4x4_16b_bf16 v[104:107], v[128:129], v[120:121], 0 cbsz:4 abid:2
    v_mfma_f32_4x4x4_16b_bf16 v[108:111], v[128:129], v[122:123], 0 cbsz:4 abid:2
    s_set_gpr_idx_on s67, gpr_idx(SRC2,DST)
    v_pk_fma_f32 v[32:33], v[112:113], v[72:73], v[32:33] op_sel:[0,1,0] op_sel_hi:[1,1,1]
    v_pk_fma_f32 v[34:35], v[114:115], v[72:73], v[34:35] op_sel:[0,1,0] op_sel_hi:[1,1,1]
    v_pk_fma_f32 v[36:37], v[116:117], v[88:89], v[36:37] op_sel:[0,1,0] op_sel_hi:[1,1,1]
    v_pk_fma_f32 v[38:39], v[118:119], v[88:89], v[38:39] op_sel:[0,1,0] op_sel_hi:[1,1,1]
    s_set_gpr_idx_off
    v_readlane_b32 s81, v4, 11
    s_add_u32 m0, s38, 2048
    s_and_b32 s66, s80, s65
    buffer_load_dwordx4 v137, s[12:15], s66 offen lds
    s_waitcnt vmcnt(6)
    ds_read_b64_tr_b16 v[120:121], v138 offset:4096
    ds_read_b64_tr_b16 v[122:123], v139 offset:4096
    s_and_b32 s67, s72, 0x38
    s_waitcnt lgkmcnt(2)
    v_mfma_f32_4x4x4_16b_bf16 v[112:115], v[128:129], v[124:125], 0 cbsz:4 abid:3
    v_mfma_f32_4x4x4_16b_bf16 v[116:119], v[128:129], v[126:127], 0 cbsz:4 abid:3
    s_set_gpr_idx_on s67, gpr_idx(SRC2,DST)
    v_pk_fma_f32 v[32:33], v[104:105], v[74:75], v[32:33] op_sel:[0,0,0] op_sel_hi:[1,0,1]
    v_pk_fma_f32 v[34:35], v[106:107], v[74:75], v[34:35] op_sel:[0,0,0] op_sel_hi:[1,0,1]
    v_pk_fma_f32 v[36:37], v[108:109], v[90:91], v[36:37] op_sel:[0,0,0] op_sel_hi:[1,0,1]
    v_pk_fma_f32 v[38:39], v[110:111], v[90:91], v[38:39] op_sel:[0,0,0] op_sel_hi:[1,0,1]
    s_set_gpr_idx_off
    v_readlane_b32 s82, v4, 12
    s_add_u32 m0, s38, 3072
    s_and_b32 s66, s81, s65
    buffer_load_dwordx4 v137, s[12:15], s66 offen lds
    s_waitcnt vmcnt(6)
    ds_read_b64_tr_b16 v[124:125], v138 offset:5120
    ds_read_b64_tr_b16 v[126:127], v139 offset:5120
    s_and_b32 s67, s73, 0x38
    s_waitcnt lgkmcnt(2)
    v_mfma_f32_4x4x4_16b_bf16 v[104:107], v[128:129], v[120:121], 0 cbsz:4 abid:4
    v_mfma_f32_4x4x4_16b_bf16 v[108:111], v[128:129], v[122:123], 0 cbsz:4 abid:4
    s_set_gpr_idx_on s67, gpr_idx(SRC2,DST)
    v_pk_fma_f32 v[32:33], v[112:113], v[74:75], v[32:33] op_sel:[0,1,0] op_sel_hi:[1,1,1]
    v_pk_fma_f32 v[34:35], v[114:115], v[74:75], v[34:35] op_sel:[0,1,0] op_sel_hi:[1,1,1]
    v_pk_fma_f32 v[36:37], v[116:117], v[90:91], v[36:37] op_sel:[0,1,0] op_sel_hi:[1,1,1]
    v_pk_fma_f32 v[38:39], v[118:119], v[90:91], v[38:39] op_sel:[0,1,0] op_sel_hi:[1,1,1]
    s_set_gpr_idx_off
    v_readlane_b32 s83, v4, 13
    s_add_u32 m0, s38, 4096
    s_and_b32 s66, s82, s65
    buffer_load_dwordx4 v137, s[12:15], s66 offen lds
    s_waitcnt vmcnt(6)
    ds_read_b64_tr_b16 v[120:121], v138 offset:6144
    ds_read_b64_tr_b16 v[122:123], v139 offset:6144
    s_and_b32 s67, s74, 0x38
    s_waitcnt lgkmcnt(2)
    v_mfma_f32_4x4x4_16b_bf16 v[112:115], v[128:129], v[124:125], 0 cbsz:4 abid:5
    v_mfma_f32_4x4x4_16b_bf16 v[116:119], v[128:129], v[126:127], 0 cbsz:4 abid:5
    s_set_gpr_idx_on s67, gpr_idx(SRC2,DST)
    v_pk_fma_f32 v[32:33], v[104:105], v[76:77], v[32:33] op_sel:[0,0,0] op_sel_hi:[1,0,1]
    v_pk_fma_f32 v[34:35], v[106:107], v[76:77], v[34:35] op_sel:[0,0,0] op_sel_hi:[1,0,1]
    v_pk_fma_f32 v[36:37], v[108:109], v[92:93], v[36:37] op_sel:[0,0,0] op_sel_hi:[1,0,1]
    v_pk_fma_f32 v[38:39], v[110:111], v[92:93], v[38:39] op_sel:[0,0,0] op_sel_hi:[1,0,1]
    s_set_gpr_idx_off
    s_waitcnt lgkmcnt(0)
    v_lshrrev_b32 v134, 24, v6
    v_lshrrev_b32 v135, 24, v7
    v_mad_u32_u24 v134, v134, 48, v133
    v_mad_u32_u24 v135, v135, 48, s61
    s_mov_b64 exec, s[50:51]
    ds_read_b128 v[140:143], v134
    s_mov_b64 exec, s[52:53]
    ds_read_b128 v[144:147], v134
    s_mov_b64 exec, s[44:45]
    ds_read_b64 v[148:149], v135
    s_mov_b64 exec, s[46:47]
    ds_read_b64 v[150:151], v135
    s_mov_b64 exec, s[42:43]
    ds_read_b64 v[152:153], v135
    s_mov_b64 exec, s[48:49]
    ds_read_b64 v[154:155], v135
    s_mov_b64 exec, -1
    v_readlane_b32 s84, v4, 14
    s_add_u32 m0, s38, 5120
    s_and_b32 s66, s83, s65
    buffer_load_dwordx4 v137, s[12:15], s66 offen lds
    s_waitcnt vmcnt(6)
    ds_read_b64_tr_b16 v[124:125], v138 offset:7168
    ds_read_b64_tr_b16 v[126:127], v139 offset:7168
    s_and_b32 s67, s75, 0x38
    s_waitcnt lgkmcnt(2)
    v_mfma_f32_4x4x4_16b_bf16 v[104:107], v[128:129], v[120:121], 0 cbsz:4 abid:6
    v_mfma_f32_4x4x4_16b_bf16 v[108:111], v[128:129], v[122:123], 0 cbsz:4 abid:6
    s_set_gpr_idx_on s67, gpr_idx(SRC2,DST)
    v_pk_fma_f32 v[32:33], v[112:113], v[76:77], v[32:33] op_sel:[0,1,0] op_sel_hi:[1,1,1]
    v_pk_fma_f32 v[34:35], v[114:115], v[76:77], v[34:35] op_sel:[0,1,0] op_sel_hi:[1,1,1]
    v_pk_fma_f32 v[36:37], v[116:117], v[92:93], v[36:37] op_sel:[0,1,0] op_sel_hi:[1,1,1]
    v_pk_fma_f32 v[38:39], v[118:119], v[92:93], v[38:39] op_sel:[0,1,0] op_sel_hi:[1,1,1]
    s_set_gpr_idx_off
    v_readlane_b32 s85, v4, 15
    s_add_u32 m0, s38, 6144
    s_and_b32 s66, s84, s65
    buffer_load_dwordx4 v137, s[12:15], s66 offen lds
    s_waitcnt vmcnt(6)
    ds_read_b64_tr_b16 v[120:121], v138 offset:0
    ds_read_b64_tr_b16 v[122:123], v139 offset:0
    s_and_b32 s67, s76, 0x38
    s_waitcnt lgkmcnt(2)
    v_mfma_f32_4x4x4_16b_bf16 v[112:115], v[128:129], v[124:125], 0 cbsz:4 abid:7
    v_mfma_f32_4x4x4_16b_bf16 v[116:119], v[128:129], v[126:127], 0 cbsz:4 abid:7
    s_set_gpr_idx_on s67, gpr_idx(SRC2,DST)
    v_pk_fma_f32 v[32:33], v[104:105], v[78:79], v[32:33] op_sel:[0,0,0] op_sel_hi:[1,0,1]
    v_pk_fma_f32 v[34:35], v[106:107], v[78:79], v[34:35] op_sel:[0,0,0] op_sel_hi:[1,0,1]
    v_pk_fma_f32 v[36:37], v[108:109], v[94:95], v[36:37] op_sel:[0,0,0] op_sel_hi:[1,0,1]
    v_pk_fma_f32 v[38:39], v[110:111], v[94:95], v[38:39] op_sel:[0,0,0] op_sel_hi:[1,0,1]
    s_set_gpr_idx_off
    v_readlane_b32 s70, v4, 16
    s_add_u32 m0, s38, 7168
    s_and_b32 s66, s85, s65
    buffer_load_dwordx4 v137, s[12:15], s66 offen lds
    s_waitcnt vmcnt(6)
    ds_read_b64_tr_b16 v[124:125], v138 offset:1024
    ds_read_b64_tr_b16 v[126:127], v139 offset:1024
    s_and_b32 s67, s77, 0x38
    s_waitcnt lgkmcnt(2)
    v_mfma_f32_4x4x4_16b_bf16 v[104:107], v[128:129], v[120:121], 0 cbsz:4 abid:8
    v_mfma_f32_4x4x4_16b_bf16 v[108:111], v[128:129], v[122:123], 0 cbsz:4 abid:8
    s_set_gpr_idx_on s67, gpr_idx(SRC2,DST)
    v_pk_fma_f32 v[32:33], v[112:113], v[78:79], v[32:33] op_sel:[0,1,0] op_sel_hi:[1,1,1]
    v_pk_fma_f32 v[34:35], v[114:115], v[78:79], v[34:35] op_sel:[0,1,0] op_sel_hi:[1,1,1]
    v_pk_fma_f32 v[36:37], v[116:117], v[94:95], v[36:37] op_sel:[0,1,0] op_sel_hi:[1,1,1]
    v_pk_fma_f32 v[38:39], v[118:119], v[94:95], v[38:39] op_sel:[0,1,0] op_sel_hi:[1,1,1]
    s_set_gpr_idx_off
    v_readlane_b32 s71, v4, 17
    s_add_u32 m0, s38, 0
    s_and_b32 s66, s70, s65
    buffer_load_dwordx4 v137, s[12:15], s66 offen lds
    s_waitcnt vmcnt(6)
    ds_read_b64_tr_b16 v[120:121], v138 offset:2048
    ds_read_b64_tr_b16 v[122:123], v139 offset:2048
    s_and_b32 s67, s78, 0x38
    s_waitcnt lgkmcnt(2)
    v_mfma_f32_4x4x4_16b_bf16 v[112:115], v[128:129], v[124:125], 0 cbsz:4 abid:9
    v_mfma_f32_4x4x4_16b_bf16 v[116:119], v[128:129], v[126:127], 0 cbsz:4 abid:9
    s_set_gpr_idx_on s67, gpr_idx(SRC2,DST)
    v_pk_fma_f32 v[32:33], v[104:105], v[80:81], v[32:33] op_sel:[0,0,0] op_sel_hi:[1,0,1]
    v_pk_fma_f32 v[34:35], v[106:107], v[80:81], v[34:35] op_sel:[0,0,0] op_sel_hi:[1,0,1]
    v_pk_fma_f32 v[36:37], v[108:109], v[96:97], v[36:37] op_sel:[0,0,0] op_sel_hi:[1,0,1]
    v_pk_fma_f32 v[38:39], v[110:111], v[96:97], v[38:39] op_sel:[0,0,0] op_sel_hi:[1,0,1]
    s_set_gpr_idx_off
    v_readlane_b32 s72, v4, 18
    s_add_u32 m0, s38, 1024
    s_and_b32 s66, s71, s65
    buffer_load_dwordx4 v137, s[12:15], s66 offen lds
    s_waitcnt vmcnt(6)
    ds_read_b64_tr_b16 v[124:125], v138 offset:3072
    ds_read_b64_tr_b16 v[126:127], v139 offset:3072
    s_and_b32 s67, s79, 0x38
    s_waitcnt lgkmcnt(2)
    v_mfma_f32_4x4x4_16b_bf16 v[104:107], v[128:129], v[120:121], 0 cbsz:4 abid:10
    v_mfma_f32_4x4x4_16b_bf16 v[108:111], v[128:129], v[122:123], 0 cbsz:4 abid:10
    s_set_gpr_idx_on s67, gpr_idx(SRC2,DST)
    v_pk_fma_f32 v[32:33], v[112:113], v[80:81], v[32:33] op_sel:[0,1,0] op_sel_hi:[1,1,1]
    v_pk_fma_f32 v[34:35], v[114:115], v[80:81], v[34:35] op_sel:[0,1,0] op_sel_hi:[1,1,1]
    v_pk_fma_f32 v[36:37], v[116:117], v[96:97], v[36:37] op_sel:[0,1,0] op_sel_hi:[1,1,1]
    v_pk_fma_f32 v[38:39], v[118:119], v[96:97], v[38:39] op_sel:[0,1,0] op_sel_hi:[1,1,1]
    s_set_gpr_idx_off
    v_readlane_b32 s73, v4, 19
    s_add_u32 m0, s38, 2048
    s_and_b32 s66, s72, s65
    buffer_load_dwordx4 v137, s[12:15], s66 offen lds
    s_waitcnt vmcnt(6)
    ds_read_b64_tr_b16 v[120:121], v138 offset:4096
    ds_read_b64_tr_b16 v[122:123], v139 offset:4096
    s_and_b32 s67, s80, 0x38
    s_waitcnt lgkmcnt(2)
    v_mfma_f32_4x4x4_16b_bf16 v[112:115], v[128:129], v[124:125], 0 cbsz:4 abid:11
    v_mfma_f32_4x4x4_16b_bf16 v[116:119], v[128:129], v[126:127], 0 cbsz:4 abid:11
    s_set_gpr_idx_on s67, gpr_idx(SRC2,DST)
    v_pk_fma_f32 v[32:33], v[104:105], v[82:83], v[32:33] op_sel:[0,0,0] op_sel_hi:[1,0,1]
    v_pk_fma_f32 v[34:35], v[106:107], v[82:83], v[34:35] op_sel:[0,0,0] op_sel_hi:[1,0,1]
    v_pk_fma_f32 v[36:37], v[108:109], v[98:99], v[36:37] op_sel:[0,0,0] op_sel_hi:[1,0,1]
    v_pk_fma_f32 v[38:39], v[110:111], v[98:99], v[38:39] op_sel:[0,0,0] op_sel_hi:[1,0,1]
    s_set_gpr_idx_off
    v_readlane_b32 s74, v4, 20
    s_add_u32 m0, s38, 3072
    s_and_b32 s66, s73, s65
    buffer_load_dwordx4 v137, s[12:15], s66 offen lds
    s_waitcnt vmcnt(6)
    ds_read_b64_tr_b16 v[124:125], v138 offset:5120
    ds_read_b64_tr_b16 v[126:127], v139 offset:5120
    s_and_b32 s67, s81, 0x38
    s_waitcnt lgkmcnt(2)
    v_mfma_f32_4x4x4_16b_bf16 v[104:107], v[128:129], v[120:121], 0 cbsz:4 abid:12
    v_mfma_f32_4x4x4_16b_bf16 v[108:111], v[128:129], v[122:123], 0 cbsz:4 abid:12
    s_set_gpr_idx_on s67, gpr_idx(SRC2,DST)
    v_pk_fma_f32 v[32:33], v[112:113], v[82:83], v[32:33] op_sel:[0,1,0] op_sel_hi:[1,1,1]
    v_pk_fma_f32 v[34:35], v[114:115], v[82:83], v[34:35] op_sel:[0,1,0] op_sel_hi:[1,1,1]
    v_pk_fma_f32 v[36:37], v[116:117], v[98:99], v[36:37] op_sel:[0,1,0] op_sel_hi:[1,1,1]
    v_pk_fma_f32 v[38:39], v[118:119], v[98:99], v[38:39] op_sel:[0,1,0] op_sel_hi:[1,1,1]
    s_set_gpr_idx_off
    v_readlane_b32 s75, v4, 21
    s_add_u32 m0, s38, 4096
    s_and_b32 s66, s74, s65
    buffer_load_dwordx4 v137, s[12:15], s66 offen lds
    s_waitcnt vmcnt(6)
    ds_read_b64_tr_b16 v[120:121], v138 offset:6144
    ds_read_b64_tr_b16 v[122:123], v139 offset:6144
    s_and_b32 s67, s82, 0x38
    s_waitcnt lgkmcnt(2)
    v_mfma_f32_4x4x4_16b_bf16 v[112:115], v[128:129], v[124:125], 0 cbsz:4 abid:13
    v_mfma_f32_4x4x4_16b_bf16 v[116:119], v[128:129], v[126:127], 0 cbsz:4 abid:13
    s_set_gpr_idx_on s67, gpr_idx(SRC2,DST)
    v_pk_fma_f32 v[32:33], v[104:105], v[84:85], v[32:33] op_sel:[0,0,0] op_sel_hi:[1,0,1]
    v_pk_fma_f32 v[34:35], v[106:107], v[84:85], v[34:35] op_sel:[0,0,0] op_sel_hi:[1,0,1]
    v_pk_fma_f32 v[36:37], v[108:109], v[100:101], v[36:37] op_sel:[0,0,0] op_sel_hi:[1,0,1]
    v_pk_fma_f32 v[38:39], v[110:111], v[100:101], v[38:39] op_sel:[0,0,0] op_sel_hi:[1,0,1]
    s_set_gpr_idx_off
    v_readlane_b32 s76, v4, 22
    s_add_u32 m0, s38, 5120
    s_and_b32 s66, s75, s65
    buffer_load_dwordx4 v137, s[12:15], s66 offen lds
    s_waitcnt vmcnt(6)
    ds_read_b64_tr_b16 v[124:125], v138 offset:7168
    ds_read_b64_tr_b16 v[126:127], v139 offset:7168
    s_and_b32 s67, s83, 0x38
    s_waitcnt lgkmcnt(2)
    v_mfma_f32_4x4x4_16b_bf16 v[104:107], v[128:129], v[120:121], 0 cbsz:4 abid:14
    v_mfma_f32_4x4x4_16b_bf16 v[108:111], v[128:129], v[122:123], 0 cbsz:4 abid:14
    s_set_gpr_idx_on s67, gpr_idx(SRC2,DST)
    v_pk_fma_f32 v[32:33], v[112:113], v[84:85], v[32:33] op_sel:[0,1,0] op_sel_hi:[1,1,1]
    v_pk_fma_f32 v[34:35], v[114:115], v[84:85], v[34:35] op_sel:[0,1,0] op_sel_hi:[1,1,1]
    v_pk_fma_f32 v[36:37], v[116:117], v[100:101], v[36:37] op_sel:[0,1,0] op_sel_hi:[1,1,1]
    v_pk_fma_f32 v[38:39], v[118:119], v[100:101], v[38:39] op_sel:[0,1,0] op_sel_hi:[1,1,1]
    s_set_gpr_idx_off
    v_readlane_b32 s77, v4, 23
    s_add_u32 m0, s38, 6144
    s_and_b32 s66, s76, s65
    buffer_load_dwordx4 v137, s[12:15], s66 offen lds
    s_waitcnt vmcnt(6)
    ds_read_b64_tr_b16 v[120:121], v138 offset:0
    ds_read_b64_tr_b16 v[122:123], v139 offset:0
    s_and_b32 s67, s84, 0x38
    s_waitcnt lgkmcnt(2)
    v_mfma_f32_4x4x4_16b_bf16 v[112:115], v[128:129], v[124:125], 0 cbsz:4 abid:15
    v_mfma_f32_4x4x4_16b_bf16 v[116:119], v[128:129], v[126:127], 0 cbsz:4 abid:15
    s_set_gpr_idx_on s67, gpr_idx(SRC2,DST)
    v_pk_fma_f32 v[32:33], v[104:105], v[86:87], v[32:33] op_sel:[0,0,0] op_sel_hi:[1,0,1]
    v_pk_fma_f32 v[34:35], v[106:107], v[86:87], v[34:35] op_sel:[0,0,0] op_sel_hi:[1,0,1]
    v_pk_fma_f32 v[36:37], v[108:109], v[102:103], v[36:37] op_sel:[0,0,0] op_sel_hi:[1,0,1]
    v_pk_fma_f32 v[38:39], v[110:111], v[102:103], v[38:39] op_sel:[0,0,0] op_sel_hi:[1,0,1]
    s_set_gpr_idx_off
    v_readlane_b32 s78, v4, 24
    s_add_u32 m0, s38, 7168
    s_and_b32 s66, s77, s65
    buffer_load_dwordx4 v137, s[12:15], s66 offen lds
    s_waitcnt vmcnt(6)
    ds_read_b64_tr_b16 v[124:125], v138 offset:1024
    ds_read_b64_tr_b16 v[126:127], v139 offset:1024
    s_and_b32 s67, s85, 0x38
    s_set_gpr_idx_on s67, gpr_idx(SRC2,DST)
    v_pk_fma_f32 v[32:33], v[112:113], v[86:87], v[32:33] op_sel:[0,1,0] op_sel_hi:[1,1,1]
    v_pk_fma_f32 v[34:35], v[114:115], v[86:87], v[34:35] op_sel:[0,1,0] op_sel_hi:[1,1,1]
    v_pk_fma_f32 v[36:37], v[116:117], v[102:103], v[36:37] op_sel:[0,1,0] op_sel_hi:[1,1,1]
    v_pk_fma_f32 v[38:39], v[118:119], v[102:103], v[38:39] op_sel:[0,1,0] op_sel_hi:[1,1,1]
    s_set_gpr_idx_off
    v_mov_b32 v4, v5
    s_sub_u32 s68, s68, 16
    s_branch K2_LOOP
K2_TAIL:
    s_waitcnt lgkmcnt(0)
    v_mfma_f32_4x4x4_16b_bf16 v[104:107], v[24:25], v[148:149], 0
    v_mfma_f32_32x32x16_bf16 v[72:87], v[140:143], v[8:11], 0
    v_add_u32 v132, 64, v132
    v_mfma_f32_4x4x4_16b_bf16 v[104:107], v[26:27], v[150:151], v[104:107]
    v_mfma_f32_32x32x16_bf16 v[88:103], v[140:143], v[16:19], 0
    v_add_u32 v130, 64, v130
    v_mfma_f32_4x4x4_16b_bf16 v[104:107], v[28:29], v[152:153], v[104:107]
    v_mfma_f32_32x32x16_bf16 v[72:87], v[144:147], v[12:15], v[72:87]
    v_add_u32 v131, 64, v131
    v_mfma_f32_4x4x4_16b_bf16 v[104:107], v[30:31], v[154:155], v[104:107]
    v_mfma_f32_32x32x16_bf16 v[88:103], v[144:147], v[20:23], v[88:103]
    ds_read_b32 v5, v132
    ds_read_b32 v6, v130
    ds_read_b32 v7, v131
    s_nop 1
    v_cvt_pk_bf16_f32 v128, v104, v105
    v_cvt_pk_bf16_f32 v129, v106, v107
    s_nop 1
    v_mfma_f32_4x4x4_16b_bf16 v[104:107], v[128:129], v[120:121], 0 cbsz:4 abid:0
    v_mfma_f32_4x4x4_16b_bf16 v[108:111], v[128:129], v[122:123], 0 cbsz:4 abid:0
    v_readlane_b32 s79, v4, 9
    s_add_u32 m0, s38, 0
    s_and_b32 s66, s78, s65
    buffer_load_dwordx4 v137, s[12:15], s66 offen lds
    s_waitcnt vmcnt(6)
    ds_read_b64_tr_b16 v[120:121], v138 offset:2048
    ds_read_b64_tr_b16 v[122:123], v139 offset:2048
    s_and_b32 s67, s70, 0x38
    s_waitcnt lgkmcnt(2)
    v_mfma_f32_4x4x4_16b_bf16 v[112:115], v[128:129], v[124:125], 0 cbsz:4 abid:1
    v_mfma_f32_4x4x4_16b_bf16 v[116:119], v[128:129], v[126:127], 0 cbsz:4 abid:1
    s_set_gpr_idx_on s67, gpr_idx(SRC2,DST)
    v_pk_fma_f32 v[32:33], v[104:105], v[72:73], v[32:33] op_sel:[0,0,0] op_sel_hi:[1,0,1]
    v_pk_fma_f32 v[34:35], v[106:107], v[72:73], v[34:35] op_sel:[0,0,0] op_sel_hi:[1,0,1]
    v_pk_fma_f32 v[36:37], v[108:109], v[88:89], v[36:37] op_sel:[0,0,0] op_sel_hi:[1,0,1]
    v_pk_fma_f32 v[38:39], v[110:111], v[88:89], v[38:39] op_sel:[0,0,0] op_sel_hi:[1,0,1]
    s_set_gpr_idx_off
    s_cmp_eq_u32 s68, 1
    s_cbranch_scc1 K2_MAIN_DONE
    v_readlane_b32 s80, v4, 10
    s_add_u32 m0, s38, 1024
    s_and_b32 s66, s79, s65
    buffer_load_dwordx4 v137, s[12:15], s66 offen lds
    s_waitcnt vmcnt(6)
    ds_read_b64_tr_b16 v[124:125], v138 offset:3072
    ds_read_b64_tr_b16 v[126:127], v139 offset:3072
    s_and_b32 s67, s71, 0x38
    s_waitcnt lgkmcnt(2)
    v_mfma_f32_4x4x4_16b_bf16 v[104:107], v[128:129], v[120:121], 0 cbsz:4 abid:2
    v_mfma_f32_4x4x4_16b_bf16 v[108:111], v[128:129], v[122:123], 0 cbsz:4 abid:2
    s_set_gpr_idx_on s67, gpr_idx(SRC2,DST)
    v_pk_fma_f32 v[32:33], v[112:113], v[72:73], v[32:33] op_sel:[0,1,0] op_sel_hi:[1,1,1]
    v_pk_fma_f32 v[34:35], v[114:115], v[72:73], v[34:35] op_sel:[0,1,0] op_sel_hi:[1,1,1]
    v_pk_fma_f32 v[36:37], v[116:117], v[88:89], v[36:37] op_sel:[0,1,0] op_sel_hi:[1,1,1]
    v_pk_fma_f32 v[38:39], v[118:119], v[88:89], v[38:39] op_sel:[0,1,0] op_sel_hi:[1,1,1]
    s_set_gpr_idx_off
    s_cmp_eq_u32 s68, 2
    s_cbranch_scc1 K2_MAIN_DONE
    v_readlane_b32 s81, v4, 11
    s_add_u32 m0, s38, 2048
    s_and_b32 s66, s80, s65
    buffer_load_dwordx4 v137, s[12:15], s66 offen lds
    s_waitcnt vmcnt(6)
    ds_read_b64_tr_b16 v[120:121], v138 offset:4096
    ds_read_b64_tr_b16 v[122:123], v139 offset:4096
    s_and_b32 s67, s72, 0x38
    s_waitcnt lgkmcnt(2)
    v_mfma_f32_4x4x4_16b_bf16 v[112:115], v[128:129], v[124:125], 0 cbsz:4 abid:3
    v_mfma_f32_4x4x4_16b_bf16 v[116:119], v[128:129], v[126:127], 0 cbsz:4 abid:3
    s_set_gpr_idx_on s67, gpr_idx(SRC2,DST)
    v_pk_fma_f32 v[32:33], v[104:105], v[74:75], v[32:33] op_sel:[0,0,0] op_sel_hi:[1,0,1]
    v_pk_fma_f32 v[34:35], v[106:107], v[74:75], v[34:35] op_sel:[0,0,0] op_sel_hi:[1,0,1]
    v_pk_fma_f32 v[36:37], v[108:109], v[90:91], v[36:37] op_sel:[0,0,0] op_sel_hi:[1,0,1]
    v_pk_fma_f32 v[38:39], v[110:111], v[90:91], v[38:39] op_sel:[0,0,0] op_sel_hi:[1,0,1]
    s_set_gpr_idx_off
    s_cmp_eq_u32 s68, 3
    s_cbranch_scc1 K2_MAIN_DONE
    v_readlane_b32 s82, v4, 12
    s_add_u32 m0, s38, 3072
    s_and_b32 s66, s81, s65
    buffer_load_dwordx4 v137, s[12:15], s66 offen lds
    s_waitcnt vmcnt(6)
    ds_read_b64_tr_b16 v[124:125], v138 offset:5120
    ds_read_b64_tr_b16 v[126:127], v139 offset:5120
    s_and_b32 s67, s73, 0x38
    s_waitcnt lgkmcnt(2)
    v_mfma_f32_4x4x4_16b_bf16 v[104:107], v[128:129], v[120:121], 0 cbsz:4 abid:4
    v_mfma_f32_4x4x4_16b_bf16 v[108:111], v[128:129], v[122:123], 0 cbsz:4 abid:4
    s_set_gpr_idx_on s67, gpr_idx(SRC2,DST)
    v_pk_fma_f32 v[32:33], v[112:113], v[74:75], v[32:33] op_sel:[0,1,0] op_sel_hi:[1,1,1]
    v_pk_fma_f32 v[34:35], v[114:115], v[74:75], v[34:35] op_sel:[0,1,0] op_sel_hi:[1,1,1]
    v_pk_fma_f32 v[36:37], v[116:117], v[90:91], v[36:37] op_sel:[0,1,0] op_sel_hi:[1,1,1]
    v_pk_fma_f32 v[38:39], v[118:119], v[90:91], v[38:39] op_sel:[0,1,0] op_sel_hi:[1,1,1]
    s_set_gpr_idx_off
    s_cmp_eq_u32 s68, 4
    s_cbranch_scc1 K2_MAIN_DONE
    v_readlane_b32 s83, v4, 13
    s_add_u32 m0, s38, 4096
    s_and_b32 s66, s82, s65
    buffer_load_dwordx4 v137, s[12:15], s66 offen lds
    s_waitcnt vmcnt(6)
    ds_read_b64_tr_b16 v[120:121], v138 offset:6144
    ds_read_b64_tr_b16 v[122:123], v139 offset:6144
    s_and_b32 s67, s74, 0x38
    s_waitcnt lgkmcnt(2)
    v_mfma_f32_4x4x4_16b_bf16 v[112:115], v[128:129], v[124:125], 0 cbsz:4 abid:5
    v_mfma_f32_4x4x4_16b_bf16 v[116:119], v[128:129], v[126:127], 0 cbsz:4 abid:5
    s_set_gpr_idx_on s67, gpr_idx(SRC2,DST)
    v_pk_fma_f32 v[32:33], v[104:105], v[76:77], v[32:33] op_sel:[0,0,0] op_sel_hi:[1,0,1]
    v_pk_fma_f32 v[34:35], v[106:107], v[76:77], v[34:35] op_sel:[0,0,0] op_sel_hi:[1,0,1]
    v_pk_fma_f32 v[36:37], v[108:109], v[92:93], v[36:37] op_sel:[0,0,0] op_sel_hi:[1,0,1]
    v_pk_fma_f32 v[38:39], v[110:111], v[92:93], v[38:39] op_sel:[0,0,0] op_sel_hi:[1,0,1]
    s_set_gpr_idx_off
    s_cmp_eq_u32 s68, 5
    s_cbranch_scc1 K2_MAIN_DONE
    s_waitcnt lgkmcnt(0)
    v_lshrrev_b32 v134, 24, v6
    v_lshrrev_b32 v135, 24, v7
    v_mad_u32_u24 v134, v134, 48, v133
    v_mad_u32_u24 v135, v135, 48, s61
    s_mov_b64 exec, s[50:51]
    ds_read_b128 v[140:143], v134
    s_mov_b64 exec, s[52:53]
    ds_read_b128 v[144:147], v134
    s_mov_b64 exec, s[44:45]
    ds_read_b64 v[148:149], v135
    s_mov_b64 exec, s[46:47]
    ds_read_b64 v[150:151], v135
    s_mov_b64 exec, s[42:43]
    ds_read_b64 v[152:153], v135
    s_mov_b64 exec, s[48:49]
    ds_read_b64 v[154:155], v135
    s_mov_b64 exec, -1
    v_readlane_b32 s84, v4, 14
    s_add_u32 m0, s38, 5120
    s_and_b32 s66, s83, s65
    buffer_load_dwordx4 v137, s[12:15], s66 offen lds
    s_waitcnt vmcnt(6)
    ds_read_b64_tr_b16 v[124:125], v138 offset:7168
    ds_read_b64_tr_b16 v[126:127], v139 offset:7168
    s_and_b32 s67, s75, 0x38
    s_waitcnt lgkmcnt(2)
    v_mfma_f32_4x4x4_16b_bf16 v[104:107], v[128:129], v[120:121], 0 cbsz:4 abid:6
    v_mfma_f32_4x4x4_16b_bf16 v[108:111], v[128:129], v[122:123], 0 cbsz:4 abid:6
    s_set_gpr_idx_on s67, gpr_idx(SRC2,DST)
    v_pk_fma_f32 v[32:33], v[112:113], v[76:77], v[32:33] op_sel:[0,1,0] op_sel_hi:[1,1,1]
    v_pk_fma_f32 v[34:35], v[114:115], v[76:77], v[34:35] op_sel:[0,1,0] op_sel_hi:[1,1,1]
    v_pk_fma_f32 v[36:37], v[116:117], v[92:93], v[36:37] op_sel:[0,1,0] op_sel_hi:[1,1,1]
    v_pk_fma_f32 v[38:39], v[118:119], v[92:93], v[38:39] op_sel:[0,1,0] op_sel_hi:[1,1,1]
    s_set_gpr_idx_off
    s_cmp_eq_u32 s68, 6
    s_cbranch_scc1 K2_MAIN_DONE
    v_readlane_b32 s85, v4, 15
    s_add_u32 m0, s38, 6144
    s_and_b32 s66, s84, s65
    buffer_load_dwordx4 v137, s[12:15], s66 offen lds
    s_waitcnt vmcnt(6)
    ds_read_b64_tr_b16 v[120:121], v138 offset:0
    ds_read_b64_tr_b16 v[122:123], v139 offset:0
    s_and_b32 s67, s76, 0x38
    s_waitcnt lgkmcnt(2)
    v_mfma_f32_4x4x4_16b_bf16 v[112:115], v[128:129], v[124:125], 0 cbsz:4 abid:7
    v_mfma_f32_4x4x4_16b_bf16 v[116:119], v[128:129], v[126:127], 0 cbsz:4 abid:7
    s_set_gpr_idx_on s67, gpr_idx(SRC2,DST)
    v_pk_fma_f32 v[32:33], v[104:105], v[78:79], v[32:33] op_sel:[0,0,0] op_sel_hi:[1,0,1]
    v_pk_fma_f32 v[34:35], v[106:107], v[78:79], v[34:35] op_sel:[0,0,0] op_sel_hi:[1,0,1]
    v_pk_fma_f32 v[36:37], v[108:109], v[94:95], v[36:37] op_sel:[0,0,0] op_sel_hi:[1,0,1]
    v_pk_fma_f32 v[38:39], v[110:111], v[94:95], v[38:39] op_sel:[0,0,0] op_sel_hi:[1,0,1]
    s_set_gpr_idx_off
    s_cmp_eq_u32 s68, 7
    s_cbranch_scc1 K2_MAIN_DONE
    v_readlane_b32 s70, v4, 16
    s_add_u32 m0, s38, 7168
    s_and_b32 s66, s85, s65
    buffer_load_dwordx4 v137, s[12:15], s66 offen lds
    s_waitcnt vmcnt(6)
    ds_read_b64_tr_b16 v[124:125], v138 offset:1024
    ds_read_b64_tr_b16 v[126:127], v139 offset:1024
    s_and_b32 s67, s77, 0x38
    s_waitcnt lgkmcnt(2)
    v_mfma_f32_4x4x4_16b_bf16 v[104:107], v[128:129], v[120:121], 0 cbsz:4 abid:8
    v_mfma_f32_4x4x4_16b_bf16 v[108:111], v[128:129], v[122:123], 0 cbsz:4 abid:8
    s_set_gpr_idx_on s67, gpr_idx(SRC2,DST)
    v_pk_fma_f32 v[32:33], v[112:113], v[78:79], v[32:33] op_sel:[0,1,0] op_sel_hi:[1,1,1]
    v_pk_fma_f32 v[34:35], v[114:115], v[78:79], v[34:35] op_sel:[0,1,0] op_sel_hi:[1,1,1]
    v_pk_fma_f32 v[36:37], v[116:117], v[94:95], v[36:37] op_sel:[0,1,0] op_sel_hi:[1,1,1]
    v_pk_fma_f32 v[38:39], v[118:119], v[94:95], v[38:39] op_sel:[0,1,0] op_sel_hi:[1,1,1]
    s_set_gpr_idx_off
    s_cmp_eq_u32 s68, 8
    s_cbranch_scc1 K2_MAIN_DONE
    v_readlane_b32 s71, v4, 17
    s_add_u32 m0, s38, 0
    s_and_b32 s66, s70, s65
    buffer_load_dwordx4 v137, s[12:15], s66 offen lds
    s_waitcnt vmcnt(6)
    ds_read_b64_tr_b16 v[120:121], v138 offset:2048
    ds_read_b64_tr_b16 v[122:123], v139 offset:2048
    s_and_b32 s67, s78, 0x38
    s_waitcnt lgkmcnt(2)
    v_mfma_f32_4x4x4_16b_bf16 v[112:115], v[128:129], v[124:125], 0 cbsz:4 abid:9
    v_mfma_f32_4x4x4_16b_bf16 v[116:119], v[128:129], v[126:127], 0 cbsz:4 abid:9
    s_set_gpr_idx_on s67, gpr_idx(SRC2,DST)
    v_pk_fma_f32 v[32:33], v[104:105], v[80:81], v[32:33] op_sel:[0,0,0] op_sel_hi:[1,0,1]
    v_pk_fma_f32 v[34:35], v[106:107], v[80:81], v[34:35] op_sel:[0,0,0] op_sel_hi:[1,0,1]
    v_pk_fma_f32 v[36:37], v[108:109], v[96:97], v[36:37] op_sel:[0,0,0] op_sel_hi:[1,0,1]
    v_pk_fma_f32 v[38:39], v[110:111], v[96:97], v[38:39] op_sel:[0,0,0] op_sel_hi:[1,0,1]
    s_set_gpr_idx_off
    s_cmp_eq_u32 s68, 9
    s_cbranch_scc1 K2_MAIN_DONE
    v_readlane_b32 s72, v4, 18
    s_add_u32 m0, s38, 1024
    s_and_b32 s66, s71, s65
    buffer_load_dwordx4 v137, s[12:15], s66 offen lds
    s_waitcnt vmcnt(6)
    ds_read_b64_tr_b16 v[124:125], v138 offset:3072
    ds_read_b64_tr_b16 v[126:127], v139 offset:3072
    s_and_b32 s67, s79, 0x38
    s_waitcnt lgkmcnt(2)
    v_mfma_f32_4x4x4_16b_bf16 v[104:107], v[128:129], v[120:121], 0 cbsz:4 abid:10
    v_mfma_f32_4x4x4_16b_bf16 v[108:111], v[128:129], v[122:123], 0 cbsz:4 abid:10
    s_set_gpr_idx_on s67, gpr_idx(SRC2,DST)
    v_pk_fma_f32 v[32:33], v[112:113], v[80:81], v[32:33] op_sel:[0,1,0] op_sel_hi:[1,1,1]
    v_pk_fma_f32 v[34:35], v[114:115], v[80:81], v[34:35] op_sel:[0,1,0] op_sel_hi:[1,1,1]
    v_pk_fma_f32 v[36:37], v[116:117], v[96:97], v[36:37] op_sel:[0,1,0] op_sel_hi:[1,1,1]
    v_pk_fma_f32 v[38:39], v[118:119], v[96:97], v[38:39] op_sel:[0,1,0] op_sel_hi:[1,1,1]
    s_set_gpr_idx_off
    s_cmp_eq_u32 s68, 10
    s_cbranch_scc1 K2_MAIN_DONE
    v_readlane_b32 s73, v4, 19
    s_add_u32 m0, s38, 2048
    s_and_b32 s66, s72, s65
    buffer_load_dwordx4 v137, s[12:15], s66 offen lds
    s_waitcnt vmcnt(6)
    ds_read_b64_tr_b16 v[120:121], v138 offset:4096
    ds_read_b64_tr_b16 v[122:123], v139 offset:4096
    s_and_b32 s67, s80, 0x38
    s_waitcnt lgkmcnt(2)
    v_mfma_f32_4x4x4_16b_bf16 v[112:115], v[128:129], v[124:125], 0 cbsz:4 abid:11
    v_mfma_f32_4x4x4_16b_bf16 v[116:119], v[128:129], v[126:127], 0 cbsz:4 abid:11
    s_set_gpr_idx_on s67, gpr_idx(SRC2,DST)
    v_pk_fma_f32 v[32:33], v[104:105], v[82:83], v[32:33] op_sel:[0,0,0] op_sel_hi:[1,0,1]
    v_pk_fma_f32 v[34:35], v[106:107], v[82:83], v[34:35] op_sel:[0,0,0] op_sel_hi:[1,0,1]
    v_pk_fma_f32 v[36:37], v[108:109], v[98:99], v[36:37] op_sel:[0,0,0] op_sel_hi:[1,0,1]
    v_pk_fma_f32 v[38:39], v[110:111], v[98:99], v[38:39] op_sel:[0,0,0] op_sel_hi:[1,0,1]
    s_set_gpr_idx_off
    s_cmp_eq_u32 s68, 11
    s_cbranch_scc1 K2_MAIN_DONE
    v_readlane_b32 s74, v4, 20
    s_add_u32 m0, s38, 3072
    s_and_b32 s66, s73, s65
    buffer_load_dwordx4 v137, s[12:15], s66 offen lds
    s_waitcnt vmcnt(6)
    ds_read_b64_tr_b16 v[124:125], v138 offset:5120
    ds_read_b64_tr_b16 v[126:127], v139 offset:5120
    s_and_b32 s67, s81, 0x38
    s_waitcnt lgkmcnt(2)
    v_mfma_f32_4x4x4_16b_bf16 v[104:107], v[128:129], v[120:121], 0 cbsz:4 abid:12
    v_mfma_f32_4x4x4_16b_bf16 v[108:111], v[128:129], v[122:123], 0 cbsz:4 abid:12
    s_set_gpr_idx_on s67, gpr_idx(SRC2,DST)
    v_pk_fma_f32 v[32:33], v[112:113], v[82:83], v[32:33] op_sel:[0,1,0] op_sel_hi:[1,1,1]
    v_pk_fma_f32 v[34:35], v[114:115], v[82:83], v[34:35] op_sel:[0,1,0] op_sel_hi:[1,1,1]
    v_pk_fma_f32 v[36:37], v[116:117], v[98:99], v[36:37] op_sel:[0,1,0] op_sel_hi:[1,1,1]
    v_pk_fma_f32 v[38:39], v[118:119], v[98:99], v[38:39] op_sel:[0,1,0] op_sel_hi:[1,1,1]
    s_set_gpr_idx_off
    s_cmp_eq_u32 s68, 12
    s_cbranch_scc1 K2_MAIN_DONE
    v_readlane_b32 s75, v4, 21
    s_add_u32 m0, s38, 4096
    s_and_b32 s66, s74, s65
    buffer_load_dwordx4 v137, s[12:15], s66 offen lds
    s_waitcnt vmcnt(6)
    ds_read_b64_tr_b16 v[120:121], v138 offset:6144
    ds_read_b64_tr_b16 v[122:123], v139 offset:6144
    s_and_b32 s67, s82, 0x38
    s_waitcnt lgkmcnt(2)
    v_mfma_f32_4x4x4_16b_bf16 v[112:115], v[128:129], v[124:125], 0 cbsz:4 abid:13
    v_mfma_f32_4x4x4_16b_bf16 v[116:119], v[128:129], v[126:127], 0 cbsz:4 abid:13
    s_set_gpr_idx_on s67, gpr_idx(SRC2,DST)
    v_pk_fma_f32 v[32:33], v[104:105], v[84:85], v[32:33] op_sel:[0,0,0] op_sel_hi:[1,0,1]
    v_pk_fma_f32 v[34:35], v[106:107], v[84:85], v[34:35] op_sel:[0,0,0] op_sel_hi:[1,0,1]
    v_pk_fma_f32 v[36:37], v[108:109], v[100:101], v[36:37] op_sel:[0,0,0] op_sel_hi:[1,0,1]
    v_pk_fma_f32 v[38:39], v[110:111], v[100:101], v[38:39] op_sel:[0,0,0] op_sel_hi:[1,0,1]
    s_set_gpr_idx_off
    s_cmp_eq_u32 s68, 13
    s_cbranch_scc1 K2_MAIN_DONE
    v_readlane_b32 s76, v4, 22
    s_add_u32 m0, s38, 5120
    s_and_b32 s66, s75, s65
    buffer_load_dwordx4 v137, s[12:15], s66 offen lds
    s_waitcnt vmcnt(6)
    ds_read_b64_tr_b16 v[124:125], v138 offset:7168
    ds_read_b64_tr_b16 v[126:127], v139 offset:7168
    s_and_b32 s67, s83, 0x38
    s_waitcnt lgkmcnt(2)
    v_mfma_f32_4x4x4_16b_bf16 v[104:107], v[128:129], v[120:121], 0 cbsz:4 abid:14
    v_mfma_f32_4x4x4_16b_bf16 v[108:111], v[128:129], v[122:123], 0 cbsz:4 abid:14
    s_set_gpr_idx_on s67, gpr_idx(SRC2,DST)
    v_pk_fma_f32 v[32:33], v[112:113], v[84:85], v[32:33] op_sel:[0,1,0] op_sel_hi:[1,1,1]
    v_pk_fma_f32 v[34:35], v[114:115], v[84:85], v[34:35] op_sel:[0,1,0] op_sel_hi:[1,1,1]
    v_pk_fma_f32 v[36:37], v[116:117], v[100:101], v[36:37] op_sel:[0,1,0] op_sel_hi:[1,1,1]
    v_pk_fma_f32 v[38:39], v[118:119], v[100:101], v[38:39] op_sel:[0,1,0] op_sel_hi:[1,1,1]
    s_set_gpr_idx_off
    s_cmp_eq_u32 s68, 14
    s_cbranch_scc1 K2_MAIN_DONE
    v_readlane_b32 s77, v4, 23
    s_add_u32 m0, s38, 6144
    s_and_b32 s66, s76, s65
    buffer_load_dwordx4 v137, s[12:15], s66 offen lds
    s_waitcnt vmcnt(6)
    ds_read_b64_tr_b16 v[120:121], v138 offset:0
    ds_read_b64_tr_b16 v[122:123], v139 offset:0
    s_and_b32 s67, s84, 0x38
    s_waitcnt lgkmcnt(2)
    v_mfma_f32_4x4x4_16b_bf16 v[112:115], v[128:129], v[124:125], 0 cbsz:4 abid:15
    v_mfma_f32_4x4x4_16b_bf16 v[116:119], v[128:129], v[126:127], 0 cbsz:4 abid:15
    s_set_gpr_idx_on s67, gpr_idx(SRC2,DST)
    v_pk_fma_f32 v[32:33], v[104:105], v[86:87], v[32:33] op_sel:[0,0,0] op_sel_hi:[1,0,1]
    v_pk_fma_f32 v[34:35], v[106:107], v[86:87], v[34:35] op_sel:[0,0,0] op_sel_hi:[1,0,1]
    v_pk_fma_f32 v[36:37], v[108:109], v[102:103], v[36:37] op_sel:[0,0,0] op_sel_hi:[1,0,1]
    v_pk_fma_f32 v[38:39], v[110:111], v[102:103], v[38:39] op_sel:[0,0,0] op_sel_hi:[1,0,1]
    s_set_gpr_idx_off
    s_cmp_eq_u32 s68, 15
    s_cbranch_scc1 K2_MAIN_DONE
    v_readlane_b32 s78, v4, 24
    s_add_u32 m0, s38, 7168
    s_and_b32 s66, s77, s65
    buffer_load_dwordx4 v137, s[12:15], s66 offen lds
    s_waitcnt vmcnt(6)
    ds_read_b64_tr_b16 v[124:125], v138 offset:1024
    ds_read_b64_tr_b16 v[126:127], v139 offset:1024
    s_and_b32 s67, s85, 0x38
    s_set_gpr_idx_on s67, gpr_idx(SRC2,DST)
    v_pk_fma_f32 v[32:33], v[112:113], v[86:87], v[32:33] op_sel:[0,1,0] op_sel_hi:[1,1,1]
    v_pk_fma_f32 v[34:35], v[114:115], v[86:87], v[34:35] op_sel:[0,1,0] op_sel_hi:[1,1,1]
    v_pk_fma_f32 v[36:37], v[116:117], v[102:103], v[36:37] op_sel:[0,1,0] op_sel_hi:[1,1,1]
    v_pk_fma_f32 v[38:39], v[118:119], v[102:103], v[38:39] op_sel:[0,1,0] op_sel_hi:[1,1,1]
    s_set_gpr_idx_off
    s_cmp_eq_u32 s68, 16
    s_cbranch_scc1 K2_MAIN_DONE
    v_mov_b32 v4, v5
K2_MAIN_DONE:
    s_mov_b64 exec, -1
    s_waitcnt vmcnt(0) lgkmcnt(0)
    s_cmp_eq_u32 s58, 1
    s_cbranch_scc1 K2_SLOW_NEXT
K2_EPI:
    v_add_u32 v134, s55, v136
    v_cvt_pk_bf16_f32 v72, v32, v36
    ds_write_b32 v134, v72 offset:0
    v_cvt_pk_bf16_f32 v73, v33, v37
    ds_write_b32 v134, v73 offset:272
    v_cvt_pk_bf16_f32 v74, v34, v38
    ds_write_b32 v134, v74 offset:544
    v_cvt_pk_bf16_f32 v75, v35, v39
    ds_write_b32 v134, v75 offset:816
    v_cvt_pk_bf16_f32 v76, v40, v44
    ds_write_b32 v134, v76 offset:1088
    v_cvt_pk_bf16_f32 v77, v41, v45
    ds_write_b32 v134, v77 offset:1360
    v_cvt_pk_bf16_f32 v78, v42, v46
    ds_write_b32 v134, v78 offset:1632
    v_cvt_pk_bf16_f32 v79, v43, v47
    ds_write_b32 v134, v79 offset:1904
    v_cvt_pk_bf16_f32 v80, v48, v52
    ds_write_b32 v134, v80 offset:2176
    v_cvt_pk_bf16_f32 v81, v49, v53
    ds_write_b32 v134, v81 offset:2448
    v_cvt_pk_bf16_f32 v82, v50, v54
    ds_write_b32 v134, v82 offset:2720
    v_cvt_pk_bf16_f32 v83, v51, v55
    ds_write_b32 v134, v83 offset:2992
    v_cvt_pk_bf16_f32 v84, v56, v60
    ds_write_b32 v134, v84 offset:3264
    v_cvt_pk_bf16_f32 v85, v57, v61
    ds_write_b32 v134, v85 offset:3536
    v_cvt_pk_bf16_f32 v86, v58, v62
    ds_write_b32 v134, v86 offset:3808
    v_cvt_pk_bf16_f32 v87, v59, v63
    ds_write_b32 v134, v87 offset:4080
    v_cvt_pk_bf16_f32 v88, v64, v68
    ds_write_b32 v134, v88 offset:4352
    v_cvt_pk_bf16_f32 v89, v65, v69
    ds_write_b32 v134, v89 offset:4624
    v_cvt_pk_bf16_f32 v90, v66, v70
    ds_write_b32 v134, v90 offset:4896
    v_cvt_pk_bf16_f32 v91, v67, v71
    ds_write_b32 v134, v91 offset:5168
    s_mul_i32 s62, s3, 40960
    s_and_b32 s63, s54, 3
    s_lshl_b32 s63, s63, 6
    s_add_u32 s62, s62, s63
    s_waitcnt vmcnt(0) lgkmcnt(0)
    s_barrier
    ds_read_b128 v[72:75], v196 offset:0
    ds_read_b128 v[76:79], v196 offset:64
    ds_read_b128 v[80:83], v196 offset:128
    ds_read_b128 v[84:87], v196 offset:192
    ds_read_b128 v[88:91], v197 offset:0
    ds_read_b128 v[92:95], v197 offset:64
    ds_read_b128 v[96:99], v197 offset:128
    ds_read_b128 v[100:103], v197 offset:192
    s_waitcnt lgkmcnt(4)
    v_mfma_f32_16x16x32_bf16 v[32:35], v[164:167], v[72:75], 0
    v_mfma_f32_16x16x32_bf16 v[32:35], v[168:171], v[76:79], v[32:35]
    v_mfma_f32_16x16x32_bf16 v[32:35], v[172:175], v[80:83], v[32:35]
    v_mfma_f32_16x16x32_bf16 v[32:35], v[176:179], v[84:87], v[32:35]
    v_mfma_f32_16x16x32_bf16 v[36:39], v[180:183], v[72:75], 0
    v_mfma_f32_16x16x32_bf16 v[36:39], v[184:187], v[76:79], v[36:39]
    v_mfma_f32_16x16x32_bf16 v[36:39], v[188:191], v[80:83], v[36:39]
    v_mfma_f32_16x16x32_bf16 v[36:39], v[192:195], v[84:87], v[36:39]
    ds_read_b128 v[72:75], v198 offset:0
    ds_read_b128 v[76:79], v198 offset:64
    ds_read_b128 v[80:83], v198 offset:128
    ds_read_b128 v[84:87], v198 offset:192
    s_waitcnt lgkmcnt(4)
    v_mfma_f32_16x16x32_bf16 v[40:43], v[164:167], v[88:91], 0
    v_mfma_f32_16x16x32_bf16 v[40:43], v[168:171], v[92:95], v[40:43]
    v_mfma_f32_16x16x32_bf16 v[40:43], v[172:175], v[96:99], v[40:43]
    v_mfma_f32_16x16x32_bf16 v[40:43], v[176:179], v[100:103], v[40:43]
    v_mfma_f32_16x16x32_bf16 v[44:47], v[180:183], v[88:91], 0
    v_mfma_f32_16x16x32_bf16 v[44:47], v[184:187], v[92:95], v[44:47]
    v_mfma_f32_16x16x32_bf16 v[44:47], v[188:191], v[96:99], v[44:47]
    v_mfma_f32_16x16x32_bf16 v[44:47], v[192:195], v[100:103], v[44:47]
    v_cvt_pk_bf16_f32 v48, v32, v33
    v_cvt_pk_bf16_f32 v49, v34, v35
    v_cvt_pk_bf16_f32 v50, v36, v37
    v_cvt_pk_bf16_f32 v51, v38, v39
    buffer_store_dwordx4 v[48:51], v201, s[28:31], s62 offen nt
    ds_read_b128 v[88:91], v199 offset:0
    ds_read_b128 v[92:95], v199 offset:64
    ds_read_b128 v[96:99], v199 offset:128
    ds_read_b128 v[100:103], v199 offset:192
    s_waitcnt lgkmcnt(4)
    v_mfma_f32_16x16x32_bf16 v[32:35], v[164:167], v[72:75], 0
    v_mfma_f32_16x16x32_bf16 v[32:35], v[168:171], v[76:79], v[32:35]
    v_mfma_f32_16x16x32_bf16 v[32:35], v[172:175], v[80:83], v[32:35]
    v_mfma_f32_16x16x32_bf16 v[32:35], v[176:179], v[84:87], v[32:35]
    v_mfma_f32_16x16x32_bf16 v[36:39], v[180:183], v[72:75], 0
    v_mfma_f32_16x16x32_bf16 v[36:39], v[184:187], v[76:79], v[36:39]
    v_mfma_f32_16x16x32_bf16 v[36:39], v[188:191], v[80:83], v[36:39]
    v_mfma_f32_16x16x32_bf16 v[36:39], v[192:195], v[84:87], v[36:39]
    v_cvt_pk_bf16_f32 v52, v40, v41
    v_cvt_pk_bf16_f32 v53, v42, v43
    v_cvt_pk_bf16_f32 v54, v44, v45
    v_cvt_pk_bf16_f32 v55, v46, v47
    buffer_store_dwordx4 v[52:55], v202, s[28:31], s62 offen nt
    ds_read_b128 v[72:75], v200 offset:0
    ds_read_b128 v[76:79], v200 offset:64
    ds_read_b128 v[80:83], v200 offset:128
    ds_read_b128 v[84:87], v200 offset:192
    s_waitcnt lgkmcnt(4)
    v_mfma_f32_16x16x32_bf16 v[40:43], v[164:167], v[88:91], 0
    v_mfma_f32_16x16x32_bf16 v[40:43], v[168:171], v[92:95], v[40:43]
    v_mfma_f32_16x16x32_bf16 v[40:43], v[172:175], v[96:99], v[40:43]
    v_mfma_f32_16x16x32_bf16 v[40:43], v[176:179], v[100:103], v[40:43]
    v_mfma_f32_16x16x32_bf16 v[44:47], v[180:183], v[88:91], 0
    v_mfma_f32_16x16x32_bf16 v[44:47], v[184:187], v[92:95], v[44:47]
    v_mfma_f32_16x16x32_bf16 v[44:47], v[188:191], v[96:99], v[44:47]
    v_mfma_f32_16x16x32_bf16 v[44:47], v[192:195], v[100:103], v[44:47]
    v_cvt_pk_bf16_f32 v48, v32, v33
    v_cvt_pk_bf16_f32 v49, v34, v35
    v_cvt_pk_bf16_f32 v50, v36, v37
    v_cvt_pk_bf16_f32 v51, v38, v39
    buffer_store_dwordx4 v[48:51], v203, s[28:31], s62 offen nt
    s_waitcnt lgkmcnt(0)
    v_mfma_f32_16x16x32_bf16 v[32:35], v[164:167], v[72:75], 0
    v_mfma_f32_16x16x32_bf16 v[32:35], v[168:171], v[76:79], v[32:35]
    v_mfma_f32_16x16x32_bf16 v[32:35], v[172:175], v[80:83], v[32:35]
    v_mfma_f32_16x16x32_bf16 v[32:35], v[176:179], v[84:87], v[32:35]
    v_mfma_f32_16x16x32_bf16 v[36:39], v[180:183], v[72:75], 0
    v_mfma_f32_16x16x32_bf16 v[36:39], v[184:187], v[76:79], v[36:39]
    v_mfma_f32_16x16x32_bf16 v[36:39], v[188:191], v[80:83], v[36:39]
    v_mfma_f32_16x16x32_bf16 v[36:39], v[192:195], v[84:87], v[36:39]
    v_cvt_pk_bf16_f32 v52, v40, v41
    v_cvt_pk_bf16_f32 v53, v42, v43
    v_cvt_pk_bf16_f32 v54, v44, v45
    v_cvt_pk_bf16_f32 v55, v46, v47
    buffer_store_dwordx4 v[52:55], v204, s[28:31], s62 offen nt
    s_nop 7
    v_cvt_pk_bf16_f32 v48, v32, v33
    v_cvt_pk_bf16_f32 v49, v34, v35
    v_cvt_pk_bf16_f32 v50, v36, v37
    v_cvt_pk_bf16_f32 v51, v38, v39
    buffer_store_dwordx4 v[48:51], v205, s[28:31], s62 offen nt
    s_endpgm
K2_EMPTY:
    v_and_b32 v109, 15, v1
    v_lshrrev_b32 v104, 4, v1
    s_lshr_b32 s62, s54, 2
    s_mul_i32 s62, s62, 80
    v_add_u32 v105, s62, v109
    s_movk_i32 s67, 272
    v_lshlrev_b32 v106, 4, v104
    v_add_u32 v107, 544, v106
    v_add_u32 v108, 0, v105
    v_and_b32 v109, 0xfc, v108
    ds_read_b32 v201, v109 offset:384
    v_mul_u32_u24 v109, 3277, v108
    v_lshrrev_b32 v109, 16, v109
    v_mul_u32_u24 v109, 14960, v109
    v_mad_u32_u24 v196, v108, s67, v109
    v_add_u32 v196, v196, v107
    v_add_u32 v108, 16, v105
    v_and_b32 v109, 0xfc, v108
    ds_read_b32 v202, v109 offset:384
    v_mul_u32_u24 v109, 3277, v108
    v_lshrrev_b32 v109, 16, v109
    v_mul_u32_u24 v109, 14960, v109
    v_mad_u32_u24 v197, v108, s67, v109
    v_add_u32 v197, v197, v107
    v_add_u32 v108, 32, v105
    v_and_b32 v109, 0xfc, v108
    ds_read_b32 v203, v109 offset:384
    v_mul_u32_u24 v109, 3277, v108
    v_lshrrev_b32 v109, 16, v109
    v_mul_u32_u24 v109, 14960, v109
    v_mad_u32_u24 v198, v108, s67, v109
    v_add_u32 v198, v198, v107
    v_add_u32 v108, 48, v105
    v_and_b32 v109, 0xfc, v108
    ds_read_b32 v204, v109 offset:384
    v_mul_u32_u24 v109, 3277, v108
    v_lshrrev_b32 v109, 16, v109
    v_mul_u32_u24 v109, 14960, v109
    v_mad_u32_u24 v199, v108, s67, v109
    v_add_u32 v199, v199, v107
    v_add_u32 v108, 64, v105
    v_and_b32 v109, 0xfc, v108
    ds_read_b32 v205, v109 offset:384
    v_mul_u32_u24 v109, 3277, v108
    v_lshrrev_b32 v109, 16, v109
    v_mul_u32_u24 v109, 14960, v109
    v_mad_u32_u24 v200, v108, s67, v109
    v_add_u32 v200, v200, v107
    v_and_b32 v108, 3, v1
    v_lshl_add_u32 v106, v108, 8, v106
    s_waitcnt lgkmcnt(0)
    v_add_u32 v201, v201, v106
    v_add_u32 v202, v202, v106
    v_add_u32 v203, v203, v106
    v_add_u32 v204, v204, v106
    v_add_u32 v205, v205, v106
    s_branch K2_MAIN_DONE
K2_PF:
    v_lshlrev_b32 v134, 7, v1
    s_sub_u32 s62, s3, 250
    s_lshl_b32 s62, s62, 3
    s_add_u32 s62, s62, s54
    s_lshl_b32 s62, s62, 13
    s_waitcnt lgkmcnt(0)
    s_mov_b32 s12, s4
    s_mov_b32 s13, s5
    s_mov_b32 s14, 0x9c4000
    s_mov_b32 s15, 0x00020000
    s_movk_i32 s63, 27
K2_PFL:
    buffer_load_dword v4, v134, s[12:15], s62 offen
    s_add_u32 s62, s62, 393216
    s_sub_u32 s63, s63, 1
    s_cmp_lg_u32 s63, 0
    s_cbranch_scc1 K2_PFL
    s_endpgm
K2_SLOW_INIT:
    s_mov_b32 s58, 1
    s_mov_b32 s59, 0
    s_and_b32 s62, s54, 3
    s_lshl_b32 s62, s62, 13
    s_add_u32 s63, s62, 4096
    s_waitcnt vmcnt(0)
    buffer_load_dwordx4 v[164:167], v2, s[24:27], s62 offen offset:0
    buffer_load_dwordx4 v[168:171], v2, s[24:27], s62 offen offset:1024
    buffer_load_dwordx4 v[172:175], v2, s[24:27], s62 offen offset:2048
    buffer_load_dwordx4 v[176:179], v2, s[24:27], s62 offen offset:3072
    buffer_load_dwordx4 v[180:183], v2, s[24:27], s63 offen offset:0
    buffer_load_dwordx4 v[184:187], v2, s[24:27], s63 offen offset:1024
    buffer_load_dwordx4 v[188:191], v2, s[24:27], s63 offen offset:2048
    buffer_load_dwordx4 v[192:195], v2, s[24:27], s63 offen offset:3072
    v_mov_b32 v135, v159
    s_nop 1
    v_add_u32_dpp v135, v135, v135 row_shr:1 row_mask:0xf bank_mask:0xf bound_ctrl:0
    s_nop 1
    v_add_u32_dpp v135, v135, v135 row_shr:2 row_mask:0xf bank_mask:0xf bound_ctrl:0
    s_nop 1
    v_add_u32_dpp v135, v135, v135 row_shr:4 row_mask:0xf bank_mask:0xf bound_ctrl:0
    s_nop 1
    v_add_u32_dpp v135, v135, v135 row_shr:8 row_mask:0xf bank_mask:0xf bound_ctrl:0
    s_nop 1
    v_add_u32_dpp v135, v135, v135 row_bcast:15 row_mask:0xa bank_mask:0xf
    s_nop 1
    v_add_u32_dpp v135, v135, v135 row_bcast:31 row_mask:0xc bank_mask:0xf
    s_nop 0
    v_readlane_b32 s57, v135, 63
    s_waitcnt lgkmcnt(0)
    s_barrier
    v_mov_b32 v134, 52
    v_mov_b32 v135, s57
    ds_max_u32 v134, v135
    s_waitcnt lgkmcnt(0)
    s_barrier
    ds_read_b32 v135, v134
    s_waitcnt lgkmcnt(0)
    v_readfirstlane_b32 s60, v135
    s_branch K2_SLOW_ROUND
K2_SLOW_NEXT:
    s_add_u32 s59, s59, 16
    s_cmp_ge_u32 s59, s60
    s_cbranch_scc1 K2_EPI
K2_SLOW_ROUND:
    s_barrier
    v_mov_b32 v135, 0
    s_cmp_lg_u32 s54, 0
    s_cbranch_scc1 K2_SLOW_NOCNT
    v_cmpx_gt_u32 vcc, 12, v1
    ds_write_b32 v136, v135
    s_mov_b64 exec, -1
K2_SLOW_NOCNT:
    v_add_u32 v134, s55, v136
    v_mov_b32 v6, 0xffffff
    ds_write_b32 v134, v135 offset:11952
    ds_write_b32 v134, v6 offset:10800
    v_subrev_u32 v6, s59, v156
    v_mov_b32 v4, v157
    s_mov_b32 s62, 0
    s_waitcnt lgkmcnt(0)
    s_barrier
K2_SL1:
    v_cmp_lt_u32 vcc, s62, v159
    s_cbranch_vccz K2_SL1_DONE
    v_cmp_gt_u32 s[86:87], 16, v6
    v_lshlrev_b32 v134, 2, v6
    v_add_u32 v134, s55, v134
    s_and_b64 exec, vcc, s[86:87]
    ds_write_b32 v134, v4 offset:10800
    s_mov_b64 exec, -1
    v_add_u32 v6, 1, v6
    v_add_u32 v4, 2, v4
    s_add_u32 s62, s62, 1
    s_branch K2_SL1
K2_SL1_DONE:
    s_waitcnt lgkmcnt(0)
    ds_read_b32 v104, v160
    s_waitcnt lgkmcnt(0)
    v_lshlrev_b32 v105, 2, v104
    v_mad_u32_u24 v104, v104, 40, v161
    s_mov_b64 exec, s[40:41]
    buffer_load_dwordx4 v[108:111], v104, s[16:19], 0 offen
    s_mov_b64 exec, s[42:43]
    s_mov_b32 s65, 0x80fffc00
    s_waitcnt vmcnt(0)
    buffer_load_dword v110, v105, s[20:23], 0 offen
    s_waitcnt vmcnt(0)
    v_and_b32 v134, 0xfc, v110
    ds_read_b32 v135, v134 offset:224
    v_cmp_gt_i32 s[86:87], 0, v110
    s_add_u32 s64, s55, 10208
    v_mov_b32 v6, s64
    s_waitcnt lgkmcnt(0)
    v_and_or_b32 v110, v110, s65, v135
    v_and_b32 v134, 0x1c, v135
    s_and_b64 exec, exec, s[86:87]
    ds_add_rtn_u32 v111, v134, v3
    s_waitcnt lgkmcnt(0)
    v_mul_u32_u24 v134, 5100, v134
    v_lshl_add_u32 v135, v111, 2, v134
    v_add_u32 v135, 12752, v135
    ds_write_b32 v135, v110
    v_mad_u32_u24 v135, v111, 48, v134
    s_mov_b64 exec, s[42:43]
    v_cndmask_b32 v111, v6, v135, s[86:87]
    s_mov_b64 exec, s[40:41]
    s_nop 1
    v_add_u32_dpp v104, v111, v158 quad_perm:[2,2,2,2] row_mask:0xf bank_mask:0xf
    ds_write_b128 v104, v[108:111]
    s_mov_b64 exec, -1
    s_waitcnt lgkmcnt(0)
    s_barrier
    s_branch K2_AFTER
K2_END:
    s_endpgm
K2_CODE_END:
.section .rodata,"a"
.p2align 6
.amdhsa_kernel mace_prep_kernel
  .amdhsa_next_free_vgpr 84
  .amdhsa_next_free_sgpr 72
  .amdhsa_accum_offset 84
  .amdhsa_group_segment_fixed_size 0
  .amdhsa_kernarg_size 88
  .amdhsa_user_sgpr_count 2
  .amdhsa_user_sgpr_kernarg_segment_ptr 1
  .amdhsa_system_sgpr_workgroup_id_x 1
  .amdhsa_float_denorm_mode_32 3
.end_amdhsa_kernel
.p2align 6
.amdhsa_kernel standalone__tensor_product_equiv_mace__graph_kernel
  .amdhsa_next_free_vgpr 256
  .amdhsa_next_free_sgpr 102
  .amdhsa_accum_offset 256
  .amdhsa_group_segment_fixed_size 0
  .amdhsa_kernarg_size 88
  .amdhsa_user_sgpr_count 2
  .amdhsa_user_sgpr_kernarg_segment_ptr 1
  .amdhsa_system_sgpr_workgroup_id_x 1
  .amdhsa_float_denorm_mode_32 3
.end_amdhsa_kernel
```
